```python
import torch

def _softmax(x, axis=-1):
    return torch.softmax(x, dim=axis)
def _gelu(x):
    return torch.nn.functional.gelu(x, approximate="tanh")
def _silu(x):
    return torch.nn.functional.silu(x)
def _sigmoid(x):
    return torch.sigmoid(x)
def _layernorm(x, axis=-1, eps=1e-5):
    m = x.mean(dim=axis, keepdim=True)
    v = x.var(dim=axis, keepdim=True, unbiased=False)
    return (x - m) / torch.sqrt(v + eps)
def _scatter_add(tgt, idx, src, axis=0):
    return tgt.clone().index_add_(axis, idx, src)
def _segment_sum(src, seg, n):
    out = torch.zeros((n,) + src.shape[1:], dtype=src.dtype)
    return out.index_add_(0, seg, src)
def _pad(x, pw):
    flat = tuple(v for pair in reversed(pw) for v in pair)
    return torch.nn.functional.pad(x, flat)

kernel_name = 'parallel_sum__sliding_block_cached__glu_gated_swiglu__decode'

def setup_inputs():

    _w = (lambda a: (lambda t: t.to(torch.bfloat16) if t.is_floating_point() else t)(torch.as_tensor(a)))
    def _A_setup():
        B, Sq, D = 2, 1, 512
        Hq, Hkv, Sk, Dh = 32, 32, 16384, 128
        assert Hq % Hkv == 0, (Hq, Hkv)
        return {
            "x": _w((lambda *s: torch.randn(*s, dtype=torch.bfloat16) * 0.05)(B, Sq, D)),
            "k_cache": _w((lambda *s: torch.randn(*s, dtype=torch.bfloat16) * 1.6)(B, Hkv, Sk, Dh)),
            "v_cache": _w((lambda *s: torch.randn(*s, dtype=torch.bfloat16) * 0.8)(B, Hkv, Sk, Dh)),
            "wq": _w((lambda *s: torch.randn(*s, dtype=torch.bfloat16) * 1.6)(D, Hq * Dh) * (D ** -0.5)),
            "wo": _w((lambda *s: torch.randn(*s, dtype=torch.bfloat16) * 0.8)(Hq * Dh, D) * ((Hq * Dh) ** -0.5)),
        }
    _A_in = _A_setup()

    def _B_setup():
        B, S, D, F = 2, 1, 512, 1376
        return {
            "x": _w((lambda *s: torch.randn(*s, dtype=torch.bfloat16) * 0.05)(B, S, D)),
            "w1": _w((lambda *s: torch.randn(*s, dtype=torch.bfloat16) * 0.4)(D, F) * (2.0 / D) ** 0.5),
            "w3": _w((lambda *s: torch.randn(*s, dtype=torch.bfloat16) * 0.4)(D, F) * (2.0 / D) ** 0.5),
            "w2": _w((lambda *s: torch.randn(*s, dtype=torch.bfloat16) * 0.4)(F, D) * (2.0 / F) ** 0.5),
        }
    _B_in = _B_setup()

    return {
        "A_x": _A_in["x"],
        "A_k_cache": _A_in["k_cache"],
        "A_v_cache": _A_in["v_cache"],
        "A_wq": _A_in["wq"],
        "A_wo": _A_in["wo"],
        "B_x": _B_in["x"],
        "B_w1": _B_in["w1"],
        "B_w3": _B_in["w3"],
        "B_w2": _B_in["w2"],
    }

def reference(A_x, A_k_cache, A_v_cache, A_wq, A_wo, B_x, B_w1, B_w3, B_w2):
    def _A_ref(x, k_cache, v_cache, wq, wo):
        B, Sq, D = x.shape
        Hq, Dh = 32, 128
        Hkv, Sk = k_cache.shape[1], k_cache.shape[2]
        W = min(4096, max(256, Sk // 4))
        rep = Hq // Hkv
        q = (lambda x, *d: x.permute(*d))((x @ wq).reshape(B, Sq, Hq, Dh), 0, 2, 1, 3)
        k = (lambda x, n, axis: torch.repeat_interleave(x, n, dim=axis))(k_cache[:, :, Sk - W:, :], rep, axis=1)
        v = (lambda x, n, axis: torch.repeat_interleave(x, n, dim=axis))(v_cache[:, :, Sk - W:, :], rep, axis=1)
        scores = torch.einsum("bhqd,bhkd->bhqk", q, k) * (Dh ** -0.5)
        p = _softmax(scores, axis=-1)
        o = torch.einsum("bhqk,bhkd->bhqd", p, v)
        return (lambda x, *d: x.permute(*d))(o, 0, 2, 1, 3).reshape(B, Sq, Hq * Dh) @ wo

    def _B_ref(x, w1, w3, w2):
        gate = torch.einsum("bsd,df->bsf", x, w1)
        up = torch.einsum("bsd,df->bsf", x, w3)
        h = _silu(gate) * up
        out = torch.einsum("bsf,fd->bsd", h, w2)
        return out

    x = A_x
    xn = _layernorm(x, axis=-1)
    return x + _A_ref(xn, A_k_cache, A_v_cache, A_wq, A_wo) + _B_ref(xn, B_w1, B_w3, B_w2)
```

```asm
; @launch grid=(256,1,1) block=(256,1,1) lds=156032
.amdgcn_target "amdgcn-amd-amdhsa--gfx950"
.text
.globl parallel_sum__sliding_block_cached__glu_gated_swiglu__decode_kernel
.p2align 8
.type parallel_sum__sliding_block_cached__glu_gated_swiglu__decode_kernel,@function
parallel_sum__sliding_block_cached__glu_gated_swiglu__decode_kernel:
    s_cmp_ge_u32 s2, 256
    s_cbranch_scc1 L_end
    s_load_dwordx16 s[4:19], s[0:1], 0
    s_load_dwordx8 s[20:27], s[0:1], 64
    s_and_b32 s68, s2, 31
    s_lshr_b32 s69, s2, 7
    s_bfe_u32 s77, s2, 0x20005
    v_lshrrev_b32 v9, 6, v0
    v_and_b32 v1, 63, v0
    v_lshlrev_b32 v11, 4, v1
    v_lshl_add_u32 v4, v9, 13, v11
    s_lshl_b32 s76, s77, 15
    v_add_u32 v4, s76, v4
    s_lshl_b32 s73, s69, 5
    s_add_u32 s73, s73, s68
    s_lshl_b32 s76, s73, 22
    s_add_u32 s76, s76, 0x300000
    s_mov_b32 s30, 0x100000
    s_mov_b32 s31, 0x20000
    s_mov_b32 s74, 0
    s_waitcnt lgkmcnt(0)
    s_add_u32 s28, s6, s76
    s_addc_u32 s29, s7, 0
    buffer_load_dwordx4 v[120:123], v4, s[28:31], s74 offen offset:0 nt
    buffer_load_dwordx4 v[124:127], v4, s[28:31], s74 offen offset:1024 nt
    buffer_load_dwordx4 v[128:131], v4, s[28:31], s74 offen offset:2048 nt
    buffer_load_dwordx4 v[132:135], v4, s[28:31], s74 offen offset:3072 nt
    s_mov_b64 s[48:49], s[4:5]
    s_mov_b32 s50, 0x800
    s_mov_b32 s51, 0x20000
    buffer_load_dwordx4 v[248:251], v11, s[48:51], 0 offen
    buffer_load_dwordx4 v[252:255], v11, s[48:51], 0 offen offset:1024
    s_lshr_b32 s72, s2, 5
    v_and_b32 v2, 15, v0
    v_readfirstlane_b32 s70, v9
    v_bfe_u32 v3, v0, 4, 2
    s_lshl_b32 s73, s73, 2
    s_add_u32 s73, s73, s77
    s_mov_b32 s34, 0x100000
    s_mov_b32 s54, 0x160000
    s_mov_b32 s35, 0x20000
    s_mov_b32 s55, 0x20000
    s_mov_b32 s39, 0x20000
    s_mov_b32 s75, 0
    v_mov_b32 v12, 0x102000
    s_mov_b64 s[52:53], s[26:27]
    buffer_load_dword v24, v12, s[52:55], 0 offen sc1
    s_lshr_b32 s90, s2, 3
    s_lshl_b32 s90, s90, 2
    s_bfe_u32 s87, s2, 0x20001
    s_add_u32 s90, s90, s87
    s_and_b32 s91, s2, 1
    s_lshr_b32 s77, s2, 3
    s_sub_u32 s78, s77, 11
    s_cmp_ge_u32 s77, 11
    s_cselect_b32 s78, s78, s77
    s_cselect_b32 s79, 0x400, 0
    s_cselect_b32 s89, 1, 0
    s_lshl_b32 s84, s78, 13
    s_add_u32 s84, s84, s79
    s_lshl_b32 s79, s87, 8
    s_add_u32 s84, s84, s79
    s_add_u32 s84, s84, 0x110000
    s_lshl_b32 s79, s90, 10
    s_add_u32 s79, s79, 0x140000
    s_mov_b32 s88, 0xac0
    s_cmp_eq_u32 s91, 1
    s_cselect_b32 s84, s79, s84
    s_cselect_b32 s88, 0x2000, s88
    s_cselect_b32 s78, s77, s78
    s_lshl_b32 s79, s88, 9
    s_lshl_b32 s78, s78, 8
    s_mul_i32 s77, s87, s88
    s_lshl_b32 s77, s77, 7
    s_add_u32 s77, s77, s78
    s_sub_u32 s38, s79, s77
    s_lshr_b32 s78, s90, 3
    s_cmp_ge_u32 s78, 11
    s_cselect_b32 s78, 1, 0
    s_andn2_b32 s78, s78, s91
    s_cmp_eq_u32 s78, 1
    s_cselect_b32 s38, 0, s38
    s_cselect_b32 s77, 0, s77
    s_cselect_b32 s84, 0x40000000, s84
    s_mov_b32 s85, s78
    v_lshlrev_b32 v10, 2, v9
    v_add_lshl_u32 v10, v10, v3, 3
    v_lshlrev_b32 v8, 4, v2
    v_mad_u32_u24 v5, v10, s88, v8
    s_cmp_eq_u32 s89, 1
    s_cselect_b32 s36, s18, s16
    s_cselect_b32 s37, s19, s17
    s_cmp_eq_u32 s91, 1
    s_cselect_b32 s36, s10, s36
    s_cselect_b32 s37, s11, s37
    s_add_u32 s36, s36, s77
    s_addc_u32 s37, s37, 0
    s_add_u32 s32, s8, s76
    s_addc_u32 s33, s9, 0
    s_mov_b32 s78, 0
    buffer_load_dwordx4 a[224:227], v5, s[36:39], s78 offen
    s_add_u32 s78, s78, s88
    buffer_load_dwordx4 a[228:231], v5, s[36:39], s78 offen
    s_add_u32 s78, s78, s88
    buffer_load_dwordx4 a[232:235], v5, s[36:39], s78 offen
    s_add_u32 s78, s78, s88
    buffer_load_dwordx4 a[236:239], v5, s[36:39], s78 offen
    s_add_u32 s78, s78, s88
    buffer_load_dwordx4 a[240:243], v5, s[36:39], s78 offen
    s_add_u32 s78, s78, s88
    buffer_load_dwordx4 a[244:247], v5, s[36:39], s78 offen
    s_add_u32 s78, s78, s88
    buffer_load_dwordx4 a[248:251], v5, s[36:39], s78 offen
    s_add_u32 s78, s78, s88
    buffer_load_dwordx4 a[252:255], v5, s[36:39], s78 offen
    s_mov_b32 s43, 0x20000
    s_mov_b32 s74, 0x1000
    buffer_load_dwordx4 v[136:139], v4, s[28:31], s74 offen offset:0 nt
    s_mov_b32 s47, 0x20000
    s_mov_b32 s59, 0x20000
    s_mov_b32 s63, 0x20000
    s_mov_b32 s67, 0x20000
    s_mov_b32 s42, 0x20000
    s_mov_b32 s66, 0x800
    s_lshl_b32 s76, s68, 17
    s_add_u32 s40, s12, s76
    s_addc_u32 s41, s13, 0
    s_xor_b32 s93, s91, 1
    s_sub_u32 s94, s90, 56
    s_cmp_lt_u32 s94, 6
    s_cselect_b32 s76, s93, 0
    s_sub_u32 s80, s90, 0x58
    s_lshl_b32 s77, s80, 15
    s_mov_b32 s71, s80
    s_mov_b32 s89, 0
    s_cmp_eq_u32 s85, 1
    s_cselect_b32 s46, 0x8000, 0
    s_cselect_b32 s77, s77, 0
    s_cselect_b32 s71, s71, 0
    s_lshl_b32 s78, s94, 14
    s_add_u32 s78, s78, 0x140000
    s_lshr_b32 s79, s94, 1
    s_add_u32 s79, s79, 40
    s_cmp_eq_u32 s76, 1
    s_cselect_b32 s46, 0x4000, s46
    s_cselect_b32 s77, s78, s77
    s_cselect_b32 s71, s79, s71
    s_cselect_b32 s85, 1, s85
    s_cselect_b32 s89, s94, 0
    s_add_u32 s78, s94, 40
    s_cmp_eq_u32 s76, 1
    s_cselect_b32 s80, s78, s80
    s_and_b32 s89, s89, 1
    s_add_u32 s44, s20, s77
    s_addc_u32 s45, s21, 0
    s_lshl_b32 s80, s80, 11
    s_add_u32 s80, s80, 0x80000
    s_cmp_eq_u32 s85, 1
    s_cselect_b32 s58, 0x160000, 0
    s_mov_b64 s[56:57], s[26:27]
    s_mov_b64 s[60:61], s[26:27]
    s_mov_b64 s[64:65], s[22:23]
    s_sub_u32 s82, s90, 0
    s_cmp_lt_u32 s82, 32
    s_cselect_b32 s86, s93, 0
    s_cmp_eq_u32 s86, 1
    s_cselect_b32 s62, 0x160000, 0
    s_bfe_u32 s81, s82, 0x10004
    s_and_b32 s82, s82, 15
    s_mov_b32 s20, 0x5040100
    s_mov_b32 s21, 0x7060302
    s_mov_b32 s22, 0x3db504f3
    s_mov_b32 s23, 0x3fb8aa3b
    v_lshl_add_u32 v8, v9, 8, v8
    v_lshl_add_u32 v6, v3, 13, v8
    v_lshl_add_u32 v8, v3, 12, v8
    s_lshl_b32 s83, s70, 15
    s_add_u32 s83, s83, 0x6180
    s_add_u32 s76, s72, 0
    s_and_b32 s76, s76, 7
    s_lshl_b32 s77, s76, 12
    s_add_u32 s4, s77, s83
    s_and_b32 s77, s77, 0x1000
    buffer_load_dwordx4 v[140:143], v4, s[28:31], s74 offen offset:1024 nt
    s_lshr_b32 s76, s76, 1
    s_lshl_b32 s76, s76, 15
    s_add_u32 s12, s76, s77
    s_add_u32 s76, s72, 1
    s_and_b32 s76, s76, 7
    s_lshl_b32 s77, s76, 12
    s_add_u32 s5, s77, s83
    s_and_b32 s77, s77, 0x1000
    s_lshr_b32 s76, s76, 1
    s_lshl_b32 s76, s76, 15
    s_add_u32 s13, s76, s77
    s_add_u32 s76, s72, 2
    s_and_b32 s76, s76, 7
    s_lshl_b32 s77, s76, 12
    s_add_u32 s6, s77, s83
    s_and_b32 s77, s77, 0x1000
    s_lshr_b32 s76, s76, 1
    s_lshl_b32 s76, s76, 15
    s_add_u32 s14, s76, s77
    s_add_u32 s76, s72, 3
    s_and_b32 s76, s76, 7
    s_lshl_b32 s77, s76, 12
    s_add_u32 s7, s77, s83
    s_and_b32 s77, s77, 0x1000
    s_lshr_b32 s76, s76, 1
    s_lshl_b32 s76, s76, 15
    s_add_u32 s15, s76, s77
    s_add_u32 s76, s72, 4
    s_and_b32 s76, s76, 7
    s_lshl_b32 s77, s76, 12
    s_add_u32 s8, s77, s83
    s_and_b32 s77, s77, 0x1000
    s_lshr_b32 s76, s76, 1
    s_lshl_b32 s76, s76, 15
    s_add_u32 s16, s76, s77
    s_add_u32 s76, s72, 5
    s_and_b32 s76, s76, 7
    s_lshl_b32 s77, s76, 12
    s_add_u32 s9, s77, s83
    s_and_b32 s77, s77, 0x1000
    s_lshr_b32 s76, s76, 1
    s_lshl_b32 s76, s76, 15
    s_add_u32 s17, s76, s77
    s_add_u32 s76, s72, 6
    s_and_b32 s76, s76, 7
    s_lshl_b32 s77, s76, 12
    s_add_u32 s10, s77, s83
    s_and_b32 s77, s77, 0x1000
    s_lshr_b32 s76, s76, 1
    s_lshl_b32 s76, s76, 15
    s_add_u32 s18, s76, s77
    s_add_u32 s76, s72, 7
    s_and_b32 s76, s76, 7
    s_lshl_b32 s77, s76, 12
    s_add_u32 s11, s77, s83
    s_and_b32 s77, s77, 0x1000
    s_lshr_b32 s76, s76, 1
    s_lshl_b32 s76, s76, 15
    s_add_u32 s19, s76, s77
    v_and_b32 v9, 1, v2
    v_cmp_eq_u32 vcc, 1, v9
    v_mov_b32 v10, 0x0c0c0100
    v_mov_b32 v11, 0x01000c0c
    v_cndmask_b32 v10, v10, v11, vcc
    buffer_load_dwordx4 v[144:147], v4, s[28:31], s74 offen offset:2048 nt
    v_mov_b32 v11, 0x0c0c0302
    v_mov_b32 v12, 0x03020c0c
    v_cndmask_b32 v11, v11, v12, vcc
    v_bfe_u32 v9, v2, 1, 2
    v_mov_b32 v12, 0x0c0c0c0c
    v_cmp_eq_u32 vcc, 0, v9
    s_nop 1
    v_cndmask_b32 v16, v12, v10, vcc
    v_cndmask_b32 v20, v12, v11, vcc
    v_cmp_eq_u32 vcc, 1, v9
    s_nop 1
    v_cndmask_b32 v17, v12, v10, vcc
    v_cndmask_b32 v21, v12, v11, vcc
    v_cmp_eq_u32 vcc, 2, v9
    s_nop 1
    v_cndmask_b32 v18, v12, v10, vcc
    v_cndmask_b32 v22, v12, v11, vcc
    v_cmp_eq_u32 vcc, 3, v9
    s_nop 1
    v_cndmask_b32 v19, v12, v10, vcc
    v_cndmask_b32 v23, v12, v11, vcc
    s_waitcnt vmcnt(11)
    v_readfirstlane_b32 s25, v24
    v_lshlrev_b32 v56, 16, v248
    v_and_b32 v57, 0xffff0000, v248
    v_lshlrev_b32 v58, 16, v249
    v_and_b32 v59, 0xffff0000, v249
    v_lshlrev_b32 v60, 16, v250
    v_and_b32 v61, 0xffff0000, v250
    v_lshlrev_b32 v62, 16, v251
    v_and_b32 v63, 0xffff0000, v251
    v_lshlrev_b32 v72, 16, v252
    v_and_b32 v73, 0xffff0000, v252
    v_lshlrev_b32 v74, 16, v253
    v_and_b32 v75, 0xffff0000, v253
    v_lshlrev_b32 v76, 16, v254
    v_and_b32 v77, 0xffff0000, v254
    v_lshlrev_b32 v78, 16, v255
    v_and_b32 v79, 0xffff0000, v255
    s_add_u32 s25, s25, 1
    s_and_b32 s92, s25, 7
    s_and_b32 s24, s25, 0x3ff
    v_add_f32 v9, v56, v57
    v_add_f32 v10, v58, v59
    v_add_f32 v11, v60, v61
    v_add_f32 v12, v62, v63
    v_add_f32 v40, v72, v73
    v_add_f32 v41, v74, v75
    v_add_f32 v42, v76, v77
    v_add_f32 v43, v78, v79
    v_add_f32 v9, v9, v10
    buffer_load_dwordx4 v[148:151], v4, s[28:31], s74 offen offset:3072 nt
    v_add_f32 v11, v11, v12
    v_add_f32 v40, v40, v41
    v_add_f32 v42, v42, v43
    v_add_f32 v9, v9, v11
    v_add_f32 v40, v40, v42
    v_mov_b32 v13, 0x3b000000
    s_nop 0
    v_add_f32_dpp v9, v9, v9 row_ror:8 row_mask:0xf bank_mask:0xf
    v_add_f32_dpp v40, v40, v40 row_ror:8 row_mask:0xf bank_mask:0xf
    s_nop 0
    v_add_f32_dpp v9, v9, v9 row_ror:4 row_mask:0xf bank_mask:0xf
    v_add_f32_dpp v40, v40, v40 row_ror:4 row_mask:0xf bank_mask:0xf
    s_nop 0
    v_add_f32_dpp v9, v9, v9 row_ror:2 row_mask:0xf bank_mask:0xf
    v_add_f32_dpp v40, v40, v40 row_ror:2 row_mask:0xf bank_mask:0xf
    s_nop 0
    v_add_f32_dpp v9, v9, v9 row_ror:1 row_mask:0xf bank_mask:0xf
    v_add_f32_dpp v40, v40, v40 row_ror:1 row_mask:0xf bank_mask:0xf
    s_nop 0
    v_add_f32_dpp v9, v9, v9 row_bcast:15 row_mask:0xa bank_mask:0xf
    v_add_f32_dpp v40, v40, v40 row_bcast:15 row_mask:0xa bank_mask:0xf
    s_nop 0
    v_add_f32_dpp v9, v9, v9 row_bcast:31 row_mask:0xc bank_mask:0xf
    v_add_f32_dpp v40, v40, v40 row_bcast:31 row_mask:0xc bank_mask:0xf
    v_readlane_b32 s76, v9, 63
    v_readlane_b32 s77, v40, 63
    s_nop 0
    v_mul_f32 v10, s76, v13
    v_mul_f32 v41, s77, v13
    v_sub_f32 v64, v56, v10
    v_sub_f32 v65, v57, v10
    v_sub_f32 v66, v58, v10
    v_sub_f32 v67, v59, v10
    v_sub_f32 v68, v60, v10
    v_sub_f32 v69, v61, v10
    v_sub_f32 v70, v62, v10
    v_sub_f32 v71, v63, v10
    v_sub_f32 v80, v72, v41
    v_sub_f32 v81, v73, v41
    v_sub_f32 v82, v74, v41
    v_sub_f32 v83, v75, v41
    v_sub_f32 v84, v76, v41
    v_sub_f32 v85, v77, v41
    v_sub_f32 v86, v78, v41
    v_sub_f32 v87, v79, v41
    v_mul_f32 v9, v64, v64
    v_mul_f32 v40, v80, v80
    v_fmac_f32 v9, v65, v65
    v_fmac_f32 v40, v81, v81
    v_fmac_f32 v9, v66, v66
    v_fmac_f32 v40, v82, v82
    v_fmac_f32 v9, v67, v67
    v_fmac_f32 v40, v83, v83
    v_fmac_f32 v9, v68, v68
    s_mov_b32 s74, 0x80000
    buffer_load_dwordx4 v[152:155], v4, s[28:31], s74 offen offset:0 nt
    s_mov_b32 m0, s4
    s_nop 0
    buffer_load_dwordx4 v6, s[40:43], s12 offen offset:0  lds
    v_fmac_f32 v40, v84, v84
    v_fmac_f32 v9, v69, v69
    v_fmac_f32 v40, v85, v85
    v_fmac_f32 v9, v70, v70
    v_fmac_f32 v40, v86, v86
    v_fmac_f32 v9, v71, v71
    v_fmac_f32 v40, v87, v87
    s_nop 0
    s_nop 0
    v_add_f32_dpp v9, v9, v9 row_ror:8 row_mask:0xf bank_mask:0xf
    v_add_f32_dpp v40, v40, v40 row_ror:8 row_mask:0xf bank_mask:0xf
    s_nop 0
    v_add_f32_dpp v9, v9, v9 row_ror:4 row_mask:0xf bank_mask:0xf
    v_add_f32_dpp v40, v40, v40 row_ror:4 row_mask:0xf bank_mask:0xf
    s_nop 0
    v_add_f32_dpp v9, v9, v9 row_ror:2 row_mask:0xf bank_mask:0xf
    v_add_f32_dpp v40, v40, v40 row_ror:2 row_mask:0xf bank_mask:0xf
    s_nop 0
    v_add_f32_dpp v9, v9, v9 row_ror:1 row_mask:0xf bank_mask:0xf
    v_add_f32_dpp v40, v40, v40 row_ror:1 row_mask:0xf bank_mask:0xf
    s_nop 0
    v_add_f32_dpp v9, v9, v9 row_bcast:15 row_mask:0xa bank_mask:0xf
    v_add_f32_dpp v40, v40, v40 row_bcast:15 row_mask:0xa bank_mask:0xf
    s_nop 0
    v_add_f32_dpp v9, v9, v9 row_bcast:31 row_mask:0xc bank_mask:0xf
    v_add_f32_dpp v40, v40, v40 row_bcast:31 row_mask:0xc bank_mask:0xf
    v_readlane_b32 s76, v9, 63
    v_readlane_b32 s77, v40, 63
    s_nop 0
    v_mul_f32 v11, s76, v13
    v_mul_f32 v42, s77, v13
    v_cvt_pk_bf16_f32 v9, v10, v11
    v_cvt_pk_bf16_f32 v40, v41, v42
    v_lshlrev_b32 v10, 16, v9
    v_lshlrev_b32 v41, 16, v40
    v_and_b32 v11, 0xffff0000, v9
    v_and_b32 v42, 0xffff0000, v40
    v_add_f32 v11, 0x3727c5ac, v11
    v_add_f32 v42, 0x3727c5ac, v42
    v_cvt_pk_bf16_f32 v11, v11, v11
    v_cvt_pk_bf16_f32 v42, v42, v42
    v_lshlrev_b32 v11, 16, v11
    v_lshlrev_b32 v42, 16, v42
    v_sqrt_f32 v11, v11
    v_sqrt_f32 v42, v42
    s_nop 0
    s_nop 0
    v_cvt_pk_bf16_f32 v11, v11, v11
    v_cvt_pk_bf16_f32 v42, v42, v42
    v_lshlrev_b32 v11, 16, v11
    v_lshlrev_b32 v42, 16, v42
    buffer_load_dwordx4 v[156:159], v4, s[28:31], s74 offen offset:1024 nt
    v_rcp_f32 v12, v11
    v_rcp_f32 v43, v42
    v_sub_f32 v64, v56, v10
    v_sub_f32 v65, v57, v10
    v_sub_f32 v66, v58, v10
    v_sub_f32 v67, v59, v10
    v_sub_f32 v68, v60, v10
    v_sub_f32 v69, v61, v10
    v_sub_f32 v70, v62, v10
    v_sub_f32 v71, v63, v10
    v_cvt_pk_bf16_f32 v56, v64, v65
    v_cvt_pk_bf16_f32 v58, v66, v67
    v_cvt_pk_bf16_f32 v60, v68, v69
    v_cvt_pk_bf16_f32 v62, v70, v71
    v_lshlrev_b32 v64, 16, v56
    v_and_b32 v65, 0xffff0000, v56
    v_lshlrev_b32 v66, 16, v58
    v_and_b32 v67, 0xffff0000, v58
    v_lshlrev_b32 v68, 16, v60
    v_and_b32 v69, 0xffff0000, v60
    v_lshlrev_b32 v70, 16, v62
    v_and_b32 v71, 0xffff0000, v62
    v_mul_f32 v56, v64, v12
    v_mul_f32 v57, v65, v12
    v_mul_f32 v58, v66, v12
    v_mul_f32 v59, v67, v12
    v_mul_f32 v60, v68, v12
    v_mul_f32 v61, v69, v12
    v_mul_f32 v62, v70, v12
    v_mul_f32 v63, v71, v12
    v_fma_f32 v64, -v56, v11, v64
    v_fma_f32 v65, -v57, v11, v65
    v_fma_f32 v66, -v58, v11, v66
    v_fma_f32 v67, -v59, v11, v67
    v_fma_f32 v68, -v60, v11, v68
    v_fma_f32 v69, -v61, v11, v69
    v_fma_f32 v70, -v62, v11, v70
    v_fma_f32 v71, -v63, v11, v71
    v_fmac_f32 v56, v64, v12
    v_fmac_f32 v57, v65, v12
    v_fmac_f32 v58, v66, v12
    v_fmac_f32 v59, v67, v12
    v_fmac_f32 v60, v68, v12
    v_fmac_f32 v61, v69, v12
    v_fmac_f32 v62, v70, v12
    v_fmac_f32 v63, v71, v12
    v_cvt_pk_bf16_f32 v248, v56, v57
    v_cvt_pk_bf16_f32 v249, v58, v59
    v_cvt_pk_bf16_f32 v250, v60, v61
    v_cvt_pk_bf16_f32 v251, v62, v63
    v_sub_f32 v80, v72, v41
    buffer_load_dwordx4 v[160:163], v4, s[28:31], s74 offen offset:2048 nt
    v_sub_f32 v81, v73, v41
    v_sub_f32 v82, v74, v41
    v_sub_f32 v83, v75, v41
    v_sub_f32 v84, v76, v41
    v_sub_f32 v85, v77, v41
    v_sub_f32 v86, v78, v41
    v_sub_f32 v87, v79, v41
    v_cvt_pk_bf16_f32 v72, v80, v81
    v_cvt_pk_bf16_f32 v74, v82, v83
    v_cvt_pk_bf16_f32 v76, v84, v85
    v_cvt_pk_bf16_f32 v78, v86, v87
    v_lshlrev_b32 v80, 16, v72
    v_and_b32 v81, 0xffff0000, v72
    v_lshlrev_b32 v82, 16, v74
    v_and_b32 v83, 0xffff0000, v74
    v_lshlrev_b32 v84, 16, v76
    v_and_b32 v85, 0xffff0000, v76
    v_lshlrev_b32 v86, 16, v78
    v_and_b32 v87, 0xffff0000, v78
    v_mul_f32 v72, v80, v43
    v_mul_f32 v73, v81, v43
    v_mul_f32 v74, v82, v43
    v_mul_f32 v75, v83, v43
    v_mul_f32 v76, v84, v43
    v_mul_f32 v77, v85, v43
    v_mul_f32 v78, v86, v43
    v_mul_f32 v79, v87, v43
    v_fma_f32 v80, -v72, v42, v80
    v_fma_f32 v81, -v73, v42, v81
    v_fma_f32 v82, -v74, v42, v82
    v_fma_f32 v83, -v75, v42, v83
    v_fma_f32 v84, -v76, v42, v84
    v_fma_f32 v85, -v77, v42, v85
    v_fma_f32 v86, -v78, v42, v86
    v_fma_f32 v87, -v79, v42, v87
    v_fmac_f32 v72, v80, v43
    v_fmac_f32 v73, v81, v43
    v_fmac_f32 v74, v82, v43
    v_fmac_f32 v75, v83, v43
    v_fmac_f32 v76, v84, v43
    v_fmac_f32 v77, v85, v43
    v_fmac_f32 v78, v86, v43
    v_fmac_f32 v79, v87, v43
    v_cvt_pk_bf16_f32 v252, v72, v73
    v_cvt_pk_bf16_f32 v253, v74, v75
    v_cvt_pk_bf16_f32 v254, v76, v77
    v_cvt_pk_bf16_f32 v255, v78, v79
    s_lshl_b32 s76, s70, 11
    v_lshl_add_u32 v9, v1, 4, s76
    ds_write_b128 v9, v[248:251] offset:0
    ds_write_b128 v9, v[252:255] offset:1024
    s_mul_i32 s76, s70, 0x840
    s_lshl_b32 s77, s87, 8
    buffer_load_dwordx4 v[164:167], v4, s[28:31], s74 offen offset:3072 nt
    buffer_load_dwordx4 v6, s[40:43], s12 offen offset:1024  lds
    s_add_u32 s76, s76, s77
    v_lshrrev_b32 v9, 3, v2
    v_lshl_add_u32 v9, v9, 10, s76
    v_lshl_add_u32 v9, v3, 4, v9
    s_waitcnt lgkmcnt(0)
    ds_read_b128 v[248:251], v9 offset:0
    v_lshrrev_b32 v11, 1, v3
    v_and_b32 v12, 1, v3
    v_lshlrev_b32 v12, 4, v12
    v_lshl_add_u32 v14, v11, 9, v12
    v_lshl_add_u32 v14, v2, 5, v14
    v_lshl_add_u32 v12, v11, 7, v12
    v_and_b32 v11, 3, v2
    v_lshl_add_u32 v12, v11, 5, v12
    v_lshrrev_b32 v11, 2, v2
    v_lshl_add_u32 v12, v11, 11, v12
    s_cmp_eq_u32 s91, 1
    s_cselect_b64 vcc, -1, 0
    v_cndmask_b32 v11, v12, v14, vcc
    v_add_u32 v11, s84, v11
    v_lshlrev_b32 v9, 4, v0
    v_lshlrev_b32 v10, 4, v1
    s_waitcnt lgkmcnt(0)
    v_perm_b32 v28, v248, v248, v16
    v_perm_b32 v29, v248, v248, v17
    v_perm_b32 v30, v248, v248, v18
    v_perm_b32 v31, v248, v248, v19
    s_waitcnt vmcnt(17)
    s_nop 1
    s_mov_b32 s74, 0x81000
    buffer_load_dwordx4 v[168:171], v4, s[28:31], s74 offen offset:0 nt
    v_mfma_f32_16x16x32_bf16 v[36:39], v[28:31], a[224:227], 0
    v_perm_b32 v32, v248, v248, v20
    v_perm_b32 v33, v248, v248, v21
    v_perm_b32 v34, v248, v248, v22
    v_perm_b32 v35, v248, v248, v23
    s_waitcnt vmcnt(17)
    s_nop 1
    v_mfma_f32_16x16x32_bf16 v[36:39], v[32:35], a[228:231], v[36:39]
    v_perm_b32 v28, v249, v249, v16
    v_perm_b32 v29, v249, v249, v17
    v_perm_b32 v30, v249, v249, v18
    v_perm_b32 v31, v249, v249, v19
    s_waitcnt vmcnt(16)
    s_nop 1
    v_mfma_f32_16x16x32_bf16 v[36:39], v[28:31], a[232:235], v[36:39]
    v_perm_b32 v32, v249, v249, v20
    v_perm_b32 v33, v249, v249, v21
    v_perm_b32 v34, v249, v249, v22
    v_perm_b32 v35, v249, v249, v23
    s_waitcnt vmcnt(15)
    s_nop 1
    v_mfma_f32_16x16x32_bf16 v[36:39], v[32:35], a[236:239], v[36:39]
    v_perm_b32 v28, v250, v250, v16
    v_perm_b32 v29, v250, v250, v17
    v_perm_b32 v30, v250, v250, v18
    v_perm_b32 v31, v250, v250, v19
    s_waitcnt vmcnt(14)
    s_nop 1
    v_mfma_f32_16x16x32_bf16 v[36:39], v[28:31], a[240:243], v[36:39]
    v_perm_b32 v32, v250, v250, v20
    v_perm_b32 v33, v250, v250, v21
    v_perm_b32 v34, v250, v250, v22
    v_perm_b32 v35, v250, v250, v23
    s_waitcnt vmcnt(13)
    s_nop 1
    v_mfma_f32_16x16x32_bf16 v[36:39], v[32:35], a[244:247], v[36:39]
    v_perm_b32 v28, v251, v251, v16
    buffer_load_dwordx4 v[172:175], v4, s[28:31], s74 offen offset:1024 nt
    v_perm_b32 v29, v251, v251, v17
    v_perm_b32 v30, v251, v251, v18
    v_perm_b32 v31, v251, v251, v19
    s_waitcnt vmcnt(13)
    s_nop 1
    v_mfma_f32_16x16x32_bf16 v[36:39], v[28:31], a[248:251], v[36:39]
    v_perm_b32 v32, v251, v251, v20
    v_perm_b32 v33, v251, v251, v21
    v_perm_b32 v34, v251, v251, v22
    v_perm_b32 v35, v251, v251, v23
    s_waitcnt vmcnt(12)
    s_nop 1
    v_mfma_f32_16x16x32_bf16 v[36:39], v[32:35], a[252:255], v[36:39]
    s_nop 7
    ds_write_b128 v9, v[36:39] offset:8192
    s_waitcnt lgkmcnt(0)
    s_barrier
    s_cmp_ge_u32 s84, 0x40000000
    s_cbranch_scc1 L_pub_done
    s_cmp_lg_u32 s70, 0
    s_cbranch_scc1 L_pub_done
    ds_read_b128 v[56:59], v10 offset:8192
    ds_read_b128 v[60:63], v10 offset:9216
    ds_read_b128 v[64:67], v10 offset:10240
    ds_read_b128 v[68:71], v10 offset:11264
    s_waitcnt lgkmcnt(0)
    v_add_f32 v56, v56, v60
    v_add_f32 v64, v64, v68
    v_add_f32 v57, v57, v61
    v_add_f32 v65, v65, v69
    v_add_f32 v58, v58, v62
    v_add_f32 v66, v66, v70
    v_add_f32 v59, v59, v63
    v_add_f32 v67, v67, v71
    v_add_f32 v56, v56, v64
    v_add_f32 v57, v57, v65
    v_add_f32 v58, v58, v66
    v_add_f32 v59, v59, v67
    v_mov_b32 v60, 0x7
    v_add_u32 v56, 0x4, v56
    v_add_u32 v57, 0x4, v57
    v_add_u32 v58, 0x4, v58
    v_add_u32 v59, 0x4, v59
    v_bfi_b32 v56, v60, s24, v56
    v_bfi_b32 v57, v60, s24, v57
    v_bfi_b32 v58, v60, s24, v58
    v_bfi_b32 v59, v60, s24, v59
    buffer_store_dwordx4 v[56:59], v11, s[52:55], 0 offen sc1
L_pub_done:
    s_mov_b32 s79, 0x4000
    buffer_load_dwordx4 v[176:179], v4, s[28:31], s74 offen offset:2048 nt
    buffer_load_dwordx4 v6, s[40:43], s12 offen offset:2048  lds
    buffer_load_dwordx4 a[224:227], v8, s[44:47], 0 offen offset:0
    buffer_load_dwordx4 v[180:183], v4, s[28:31], s74 offen offset:3072 nt
    buffer_load_dwordx4 a[228:231], v8, s[44:47], 0 offen offset:1024
    s_mov_b32 s74, 0x40000
    buffer_load_dwordx4 v[184:187], v4, s[28:31], s74 offen offset:0 nt
    buffer_load_dwordx4 a[232:235], v8, s[44:47], 0 offen offset:2048
    buffer_load_dwordx4 v[188:191], v4, s[28:31], s74 offen offset:1024 nt
    buffer_load_dwordx4 v6, s[40:43], s12 offen offset:3072  lds
    buffer_load_dwordx4 a[236:239], v8, s[44:47], 0 offen offset:3072
    buffer_load_dwordx4 v[192:195], v4, s[28:31], s74 offen offset:2048 nt
    buffer_load_dwordx4 a[240:243], v8, s[44:47], s79 offen offset:0
    buffer_load_dwordx4 v[196:199], v4, s[28:31], s74 offen offset:3072 nt
    s_mov_b32 m0, s5
    s_nop 0
    buffer_load_dwordx4 v6, s[40:43], s13 offen offset:0  lds
    buffer_load_dwordx4 a[244:247], v8, s[44:47], s79 offen offset:1024
    s_mov_b32 s74, 0x41000
    buffer_load_dwordx4 v[200:203], v4, s[28:31], s74 offen offset:0 nt
    buffer_load_dwordx4 a[248:251], v8, s[44:47], s79 offen offset:2048
    buffer_load_dwordx4 v[204:207], v4, s[28:31], s74 offen offset:1024 nt
    buffer_load_dwordx4 a[252:255], v8, s[44:47], s79 offen offset:3072
    buffer_load_dwordx4 v[208:211], v4, s[28:31], s74 offen offset:2048 nt
    buffer_load_dwordx4 v6, s[40:43], s13 offen offset:1024  lds
    s_lshl_b32 s76, s68, 2
    s_add_u32 s76, s76, s70
    s_lshl_b32 s76, s76, 1
    s_add_u32 s76, s76, s69
    s_lshl_b32 s76, s76, 9
    s_add_u32 s76, s76, 0x140000
    v_and_b32 v10, 31, v1
    v_lshl_add_u32 v9, v10, 4, s76
    s_lshl_b32 s76, s71, 11
    s_add_u32 s76, s76, 0x110000
    v_and_b32 v11, 3, v2
    v_lshl_add_u32 v7, v11, 8, s76
    v_lshrrev_b32 v11, 3, v2
    v_lshl_add_u32 v7, v11, 7, v7
    v_bfe_u32 v11, v2, 2, 1
    v_xor_b32 v11, s89, v11
    v_lshl_add_u32 v7, v11, 6, v7
    v_lshl_add_u32 v7, v3, 4, v7
    s_lshl_b32 s76, s70, 9
    v_lshl_add_u32 v11, v10, 4, s76
    v_lshlrev_b32 v10, 5, v2
    buffer_load_dwordx4 v[212:215], v4, s[28:31], s74 offen offset:3072 nt
    s_mov_b32 s74, 0xc0000
    buffer_load_dwordx4 v[216:219], v4, s[28:31], s74 offen offset:0 nt
    buffer_load_dwordx4 v[220:223], v4, s[28:31], s74 offen offset:1024 nt
    buffer_load_dwordx4 v6, s[40:43], s13 offen offset:2048  lds
    buffer_load_dwordx4 v[224:227], v4, s[28:31], s74 offen offset:2048 nt
    buffer_load_dwordx4 v[228:231], v4, s[28:31], s74 offen offset:3072 nt
    buffer_load_dwordx4 v[56:59], v9, s[52:55], 0 offen sc1
    s_mov_b32 s74, 0xc1000
    s_waitcnt vmcnt(39)
    buffer_load_dwordx4 v[232:235], v4, s[28:31], s74 offen offset:0 nt
    s_waitcnt vmcnt(39)
    buffer_load_dwordx4 v6, s[40:43], s13 offen offset:3072  lds
    s_waitcnt vmcnt(39)
    buffer_load_dwordx4 v[236:239], v4, s[28:31], s74 offen offset:1024 nt
    s_waitcnt vmcnt(39)
    buffer_load_dwordx4 v[240:243], v4, s[28:31], s74 offen offset:2048 nt
    s_mov_b32 m0, s6
    s_nop 0
    s_waitcnt vmcnt(39)
    buffer_load_dwordx4 v6, s[40:43], s14 offen offset:0  lds
    s_waitcnt vmcnt(39)
    buffer_load_dwordx4 v[244:247], v4, s[28:31], s74 offen offset:3072 nt
    s_waitcnt vmcnt(39)
    buffer_load_dwordx4 a[0:3], v4, s[32:35], s75 offen offset:0 nt
    s_waitcnt vmcnt(39)
    buffer_load_dwordx4 a[4:7], v4, s[32:35], s75 offen offset:1024 nt
    s_waitcnt vmcnt(39)
    buffer_load_dwordx4 v6, s[40:43], s14 offen offset:1024  lds
    s_waitcnt vmcnt(39)
    buffer_load_dwordx4 a[8:11], v4, s[32:35], s75 offen offset:2048 nt
    s_waitcnt vmcnt(39)
    buffer_load_dwordx4 a[12:15], v4, s[32:35], s75 offen offset:3072 nt
    s_waitcnt vmcnt(11)
    s_mov_b32 s3, 0
L_qg_chk:
    v_xor_b32 v56, s92, v56
    v_xor_b32 v57, s92, v57
    v_xor_b32 v58, s92, v58
    v_xor_b32 v59, s92, v59
    v_or3_b32 v12, v56, v57, v58
    v_or_b32 v12, v12, v59
    v_and_b32 v12, 0x7, v12
    v_cmp_ne_u32 vcc, 0, v12
    s_add_u32 s3, s3, 1
    s_cbranch_vccz L_qg_ok
    s_cmp_ge_u32 s3, 0x40000
    s_cbranch_scc1 L_qg_ok
    buffer_load_dwordx4 v[56:59], v9, s[52:55], 0 offen sc1
    s_waitcnt vmcnt(0)
    s_branch L_qg_chk
L_qg_ok:
    buffer_load_dwordx4 v[40:43], v7, s[56:59], 0 offen sc1
    buffer_load_dwordx4 v[44:47], v7, s[56:59], 0 offen offset:1024 sc1
    ds_write_b128 v11, v[56:59] offset:20480
    s_waitcnt lgkmcnt(0)
    s_barrier
    ds_read_b128 v[56:59], v10 offset:20480
    ds_read_b128 v[60:63], v10 offset:20496
    ds_read_b128 v[64:67], v10 offset:20992
    ds_read_b128 v[68:71], v10 offset:21008
    s_mov_b32 s75, 0x1000
    buffer_load_dwordx4 a[16:19], v4, s[32:35], s75 offen offset:0 nt
    buffer_load_dwordx4 v6, s[40:43], s14 offen offset:2048  lds
    ds_read_b128 v[72:75], v10 offset:21504
    ds_read_b128 v[76:79], v10 offset:21520
    ds_read_b128 v[80:83], v10 offset:22016
    ds_read_b128 v[84:87], v10 offset:22032
    v_mov_b32 v13, 0xff800000
    s_waitcnt lgkmcnt(0)
    v_add_f32 v56, v56, v64
    v_add_f32 v72, v72, v80
    v_add_f32 v57, v57, v65
    v_add_f32 v73, v73, v81
    v_add_f32 v58, v58, v66
    v_add_f32 v74, v74, v82
    v_add_f32 v59, v59, v67
    v_add_f32 v75, v75, v83
    v_add_f32 v60, v60, v68
    v_add_f32 v76, v76, v84
    v_add_f32 v61, v61, v69
    v_add_f32 v77, v77, v85
    v_add_f32 v62, v62, v70
    v_add_f32 v78, v78, v86
    v_add_f32 v63, v63, v71
    v_add_f32 v79, v79, v87
    v_add_f32 v56, v56, v72
    v_add_f32 v57, v57, v73
    v_add_f32 v58, v58, v74
    v_add_f32 v59, v59, v75
    v_add_f32 v60, v60, v76
    v_add_f32 v61, v61, v77
    v_add_f32 v62, v62, v78
    v_add_f32 v63, v63, v79
    v_cvt_pk_bf16_f32 v24, v56, v57
    v_cvt_pk_bf16_f32 v25, v58, v59
    buffer_load_dwordx4 a[20:23], v4, s[32:35], s75 offen offset:1024 nt
    v_cvt_pk_bf16_f32 v26, v60, v61
    v_cvt_pk_bf16_f32 v27, v62, v63
    v_dot2_f32_bf16 v9, v120, v24, 0
    v_dot2_f32_bf16 v10, v124, v24, 0
    v_dot2_f32_bf16 v11, v128, v24, 0
    v_dot2_f32_bf16 v12, v132, v24, 0
    v_dot2_f32_bf16 v9, v121, v25, v9
    v_dot2_f32_bf16 v10, v125, v25, v10
    v_dot2_f32_bf16 v11, v129, v25, v11
    v_dot2_f32_bf16 v12, v133, v25, v12
    v_dot2_f32_bf16 v9, v122, v26, v9
    v_dot2_f32_bf16 v10, v126, v26, v10
    v_dot2_f32_bf16 v11, v130, v26, v11
    v_dot2_f32_bf16 v12, v134, v26, v12
    v_dot2_f32_bf16 v9, v123, v27, v9
    v_dot2_f32_bf16 v10, v127, v27, v10
    v_dot2_f32_bf16 v11, v131, v27, v11
    v_dot2_f32_bf16 v12, v135, v27, v12
    s_mov_b32 s74, 0x20000
    buffer_load_dwordx4 v[120:123], v4, s[28:31], s74 offen offset:0 nt
    buffer_load_dwordx4 v[124:127], v4, s[28:31], s74 offen offset:1024 nt
    buffer_load_dwordx4 v6, s[40:43], s14 offen offset:3072  lds
    buffer_load_dwordx4 v[128:131], v4, s[28:31], s74 offen offset:2048 nt
    buffer_load_dwordx4 v[132:135], v4, s[28:31], s74 offen offset:3072 nt
    v_add_f32_dpp v9, v9, v9 row_ror:8 row_mask:0xf bank_mask:0x3
    v_add_f32_dpp v11, v11, v11 row_ror:8 row_mask:0xf bank_mask:0x3
    v_add_f32_dpp v9, v10, v10 row_ror:8 row_mask:0xf bank_mask:0xc
    v_add_f32_dpp v11, v12, v12 row_ror:8 row_mask:0xf bank_mask:0xc
    s_nop 0
    v_add_f32_dpp v68, v9, v9 row_half_mirror row_mask:0xf bank_mask:0x5
    v_add_f32_dpp v68, v11, v11 row_half_mirror row_mask:0xf bank_mask:0xa
    s_nop 1
    v_add_f32_dpp v68, v68, v68 quad_perm:[1,0,3,2] row_mask:0xf bank_mask:0xf
    s_nop 1
    v_add_f32_dpp v68, v68, v68 quad_perm:[2,3,0,1] row_mask:0xf bank_mask:0xf
    v_dot2_f32_bf16 v9, v136, v24, 0
    v_dot2_f32_bf16 v10, v140, v24, 0
    v_dot2_f32_bf16 v11, v144, v24, 0
    v_dot2_f32_bf16 v12, v148, v24, 0
    v_dot2_f32_bf16 v9, v137, v25, v9
    v_dot2_f32_bf16 v10, v141, v25, v10
    v_dot2_f32_bf16 v11, v145, v25, v11
    v_dot2_f32_bf16 v12, v149, v25, v12
    v_dot2_f32_bf16 v9, v138, v26, v9
    v_dot2_f32_bf16 v10, v142, v26, v10
    v_dot2_f32_bf16 v11, v146, v26, v11
    v_dot2_f32_bf16 v12, v150, v26, v12
    v_dot2_f32_bf16 v9, v139, v27, v9
    v_dot2_f32_bf16 v10, v143, v27, v10
    v_dot2_f32_bf16 v11, v147, v27, v11
    v_dot2_f32_bf16 v12, v151, v27, v12
    s_mov_b32 s74, 0x21000
    buffer_load_dwordx4 v[136:139], v4, s[28:31], s74 offen offset:0 nt
    s_mov_b32 m0, s7
    s_nop 0
    buffer_load_dwordx4 v6, s[40:43], s15 offen offset:0  lds
    buffer_load_dwordx4 v[140:143], v4, s[28:31], s74 offen offset:1024 nt
    buffer_load_dwordx4 v[144:147], v4, s[28:31], s74 offen offset:2048 nt
    buffer_load_dwordx4 v6, s[40:43], s15 offen offset:1024  lds
    buffer_load_dwordx4 v[148:151], v4, s[28:31], s74 offen offset:3072 nt
    v_add_f32_dpp v9, v9, v9 row_ror:8 row_mask:0xf bank_mask:0x3
    v_add_f32_dpp v11, v11, v11 row_ror:8 row_mask:0xf bank_mask:0x3
    v_add_f32_dpp v9, v10, v10 row_ror:8 row_mask:0xf bank_mask:0xc
    v_add_f32_dpp v11, v12, v12 row_ror:8 row_mask:0xf bank_mask:0xc
    s_nop 0
    v_add_f32_dpp v69, v9, v9 row_half_mirror row_mask:0xf bank_mask:0x5
    v_add_f32_dpp v69, v11, v11 row_half_mirror row_mask:0xf bank_mask:0xa
    s_nop 1
    v_add_f32_dpp v69, v69, v69 quad_perm:[1,0,3,2] row_mask:0xf bank_mask:0xf
    s_nop 1
    v_add_f32_dpp v69, v69, v69 quad_perm:[2,3,0,1] row_mask:0xf bank_mask:0xf
    v_max3_f32 v13, v68, v69, v13
    v_cvt_pk_bf16_f32 v69, v68, v69
    v_lshlrev_b32 v68, 16, v69
    v_and_b32 v69, 0xffff0000, v69
    v_mul_f32 v68, s22, v68
    v_mul_f32 v69, s22, v69
    v_cvt_pk_bf16_f32 v56, v68, v69
    v_dot2_f32_bf16 v9, v152, v24, 0
    v_dot2_f32_bf16 v10, v156, v24, 0
    v_dot2_f32_bf16 v11, v160, v24, 0
    v_dot2_f32_bf16 v12, v164, v24, 0
    v_dot2_f32_bf16 v9, v153, v25, v9
    v_dot2_f32_bf16 v10, v157, v25, v10
    v_dot2_f32_bf16 v11, v161, v25, v11
    v_dot2_f32_bf16 v12, v165, v25, v12
    v_dot2_f32_bf16 v9, v154, v26, v9
    v_dot2_f32_bf16 v10, v158, v26, v10
    v_dot2_f32_bf16 v11, v162, v26, v11
    v_dot2_f32_bf16 v12, v166, v26, v12
    v_dot2_f32_bf16 v9, v155, v27, v9
    v_dot2_f32_bf16 v10, v159, v27, v10
    v_dot2_f32_bf16 v11, v163, v27, v11
    v_dot2_f32_bf16 v12, v167, v27, v12
    s_mov_b32 s74, 0xa0000
    buffer_load_dwordx4 v[152:155], v4, s[28:31], s74 offen offset:0 nt
    buffer_load_dwordx4 v[156:159], v4, s[28:31], s74 offen offset:1024 nt
    buffer_load_dwordx4 v6, s[40:43], s15 offen offset:2048  lds
    buffer_load_dwordx4 v[160:163], v4, s[28:31], s74 offen offset:2048 nt
    buffer_load_dwordx4 v[164:167], v4, s[28:31], s74 offen offset:3072 nt
    v_add_f32_dpp v9, v9, v9 row_ror:8 row_mask:0xf bank_mask:0x3
    v_add_f32_dpp v11, v11, v11 row_ror:8 row_mask:0xf bank_mask:0x3
    v_add_f32_dpp v9, v10, v10 row_ror:8 row_mask:0xf bank_mask:0xc
    v_add_f32_dpp v11, v12, v12 row_ror:8 row_mask:0xf bank_mask:0xc
    s_nop 0
    v_add_f32_dpp v68, v9, v9 row_half_mirror row_mask:0xf bank_mask:0x5
    v_add_f32_dpp v68, v11, v11 row_half_mirror row_mask:0xf bank_mask:0xa
    s_nop 1
    v_add_f32_dpp v68, v68, v68 quad_perm:[1,0,3,2] row_mask:0xf bank_mask:0xf
    s_nop 1
    v_add_f32_dpp v68, v68, v68 quad_perm:[2,3,0,1] row_mask:0xf bank_mask:0xf
    v_dot2_f32_bf16 v9, v168, v24, 0
    v_dot2_f32_bf16 v10, v172, v24, 0
    v_dot2_f32_bf16 v11, v176, v24, 0
    v_dot2_f32_bf16 v12, v180, v24, 0
    v_dot2_f32_bf16 v9, v169, v25, v9
    v_dot2_f32_bf16 v10, v173, v25, v10
    v_dot2_f32_bf16 v11, v177, v25, v11
    v_dot2_f32_bf16 v12, v181, v25, v12
    v_dot2_f32_bf16 v9, v170, v26, v9
    v_dot2_f32_bf16 v10, v174, v26, v10
    v_dot2_f32_bf16 v11, v178, v26, v11
    v_dot2_f32_bf16 v12, v182, v26, v12
    v_dot2_f32_bf16 v9, v171, v27, v9
    v_dot2_f32_bf16 v10, v175, v27, v10
    v_dot2_f32_bf16 v11, v179, v27, v11
    v_dot2_f32_bf16 v12, v183, v27, v12
    s_mov_b32 s74, 0xa1000
    buffer_load_dwordx4 v[168:171], v4, s[28:31], s74 offen offset:0 nt
    buffer_load_dwordx4 v6, s[40:43], s15 offen offset:3072  lds
    buffer_load_dwordx4 v[172:175], v4, s[28:31], s74 offen offset:1024 nt
    buffer_load_dwordx4 v[176:179], v4, s[28:31], s74 offen offset:2048 nt
    buffer_load_dwordx4 v[180:183], v4, s[28:31], s74 offen offset:3072 nt
    s_mov_b32 m0, s8
    s_nop 0
    buffer_load_dwordx4 v6, s[40:43], s16 offen offset:0  lds
    v_add_f32_dpp v9, v9, v9 row_ror:8 row_mask:0xf bank_mask:0x3
    v_add_f32_dpp v11, v11, v11 row_ror:8 row_mask:0xf bank_mask:0x3
    v_add_f32_dpp v9, v10, v10 row_ror:8 row_mask:0xf bank_mask:0xc
    v_add_f32_dpp v11, v12, v12 row_ror:8 row_mask:0xf bank_mask:0xc
    s_nop 0
    v_add_f32_dpp v69, v9, v9 row_half_mirror row_mask:0xf bank_mask:0x5
    v_add_f32_dpp v69, v11, v11 row_half_mirror row_mask:0xf bank_mask:0xa
    s_nop 1
    v_add_f32_dpp v69, v69, v69 quad_perm:[1,0,3,2] row_mask:0xf bank_mask:0xf
    s_nop 1
    v_add_f32_dpp v69, v69, v69 quad_perm:[2,3,0,1] row_mask:0xf bank_mask:0xf
    v_max3_f32 v13, v68, v69, v13
    v_cvt_pk_bf16_f32 v69, v68, v69
    v_lshlrev_b32 v68, 16, v69
    v_and_b32 v69, 0xffff0000, v69
    v_mul_f32 v68, s22, v68
    v_mul_f32 v69, s22, v69
    v_cvt_pk_bf16_f32 v57, v68, v69
    v_dot2_f32_bf16 v9, v184, v24, 0
    v_dot2_f32_bf16 v10, v188, v24, 0
    v_dot2_f32_bf16 v11, v192, v24, 0
    v_dot2_f32_bf16 v12, v196, v24, 0
    v_dot2_f32_bf16 v9, v185, v25, v9
    v_dot2_f32_bf16 v10, v189, v25, v10
    v_dot2_f32_bf16 v11, v193, v25, v11
    v_dot2_f32_bf16 v12, v197, v25, v12
    v_dot2_f32_bf16 v9, v186, v26, v9
    v_dot2_f32_bf16 v10, v190, v26, v10
    v_dot2_f32_bf16 v11, v194, v26, v11
    v_dot2_f32_bf16 v12, v198, v26, v12
    v_dot2_f32_bf16 v9, v187, v27, v9
    v_dot2_f32_bf16 v10, v191, v27, v10
    v_dot2_f32_bf16 v11, v195, v27, v11
    v_dot2_f32_bf16 v12, v199, v27, v12
    s_mov_b32 s74, 0x60000
    buffer_load_dwordx4 v[184:187], v4, s[28:31], s74 offen offset:0 nt
    buffer_load_dwordx4 v[188:191], v4, s[28:31], s74 offen offset:1024 nt
    s_waitcnt vmcnt(39)
    buffer_load_dwordx4 v6, s[40:43], s16 offen offset:1024  lds
    s_waitcnt vmcnt(39)
    buffer_load_dwordx4 v[192:195], v4, s[28:31], s74 offen offset:2048 nt
    s_waitcnt vmcnt(39)
    buffer_load_dwordx4 v[196:199], v4, s[28:31], s74 offen offset:3072 nt
    v_add_f32_dpp v9, v9, v9 row_ror:8 row_mask:0xf bank_mask:0x3
    v_add_f32_dpp v11, v11, v11 row_ror:8 row_mask:0xf bank_mask:0x3
    v_add_f32_dpp v9, v10, v10 row_ror:8 row_mask:0xf bank_mask:0xc
    v_add_f32_dpp v11, v12, v12 row_ror:8 row_mask:0xf bank_mask:0xc
    s_nop 0
    v_add_f32_dpp v68, v9, v9 row_half_mirror row_mask:0xf bank_mask:0x5
    v_add_f32_dpp v68, v11, v11 row_half_mirror row_mask:0xf bank_mask:0xa
    s_nop 1
    v_add_f32_dpp v68, v68, v68 quad_perm:[1,0,3,2] row_mask:0xf bank_mask:0xf
    s_nop 1
    v_add_f32_dpp v68, v68, v68 quad_perm:[2,3,0,1] row_mask:0xf bank_mask:0xf
    v_dot2_f32_bf16 v9, v200, v24, 0
    v_dot2_f32_bf16 v10, v204, v24, 0
    v_dot2_f32_bf16 v11, v208, v24, 0
    v_dot2_f32_bf16 v12, v212, v24, 0
    v_dot2_f32_bf16 v9, v201, v25, v9
    v_dot2_f32_bf16 v10, v205, v25, v10
    v_dot2_f32_bf16 v11, v209, v25, v11
    v_dot2_f32_bf16 v12, v213, v25, v12
    v_dot2_f32_bf16 v9, v202, v26, v9
    v_dot2_f32_bf16 v10, v206, v26, v10
    v_dot2_f32_bf16 v11, v210, v26, v11
    v_dot2_f32_bf16 v12, v214, v26, v12
    v_dot2_f32_bf16 v9, v203, v27, v9
    v_dot2_f32_bf16 v10, v207, v27, v10
    v_dot2_f32_bf16 v11, v211, v27, v11
    v_dot2_f32_bf16 v12, v215, v27, v12
    s_mov_b32 s74, 0x61000
    s_waitcnt vmcnt(39)
    buffer_load_dwordx4 v[200:203], v4, s[28:31], s74 offen offset:0 nt
    s_waitcnt vmcnt(39)
    buffer_load_dwordx4 v6, s[40:43], s16 offen offset:2048  lds
    s_waitcnt vmcnt(39)
    buffer_load_dwordx4 v[204:207], v4, s[28:31], s74 offen offset:1024 nt
    s_waitcnt vmcnt(39)
    buffer_load_dwordx4 v[208:211], v4, s[28:31], s74 offen offset:2048 nt
    s_waitcnt vmcnt(39)
    buffer_load_dwordx4 v[212:215], v4, s[28:31], s74 offen offset:3072 nt
    s_waitcnt vmcnt(39)
    buffer_load_dwordx4 v6, s[40:43], s16 offen offset:3072  lds
    v_add_f32_dpp v9, v9, v9 row_ror:8 row_mask:0xf bank_mask:0x3
    v_add_f32_dpp v11, v11, v11 row_ror:8 row_mask:0xf bank_mask:0x3
    v_add_f32_dpp v9, v10, v10 row_ror:8 row_mask:0xf bank_mask:0xc
    v_add_f32_dpp v11, v12, v12 row_ror:8 row_mask:0xf bank_mask:0xc
    s_nop 0
    v_add_f32_dpp v69, v9, v9 row_half_mirror row_mask:0xf bank_mask:0x5
    v_add_f32_dpp v69, v11, v11 row_half_mirror row_mask:0xf bank_mask:0xa
    s_nop 1
    v_add_f32_dpp v69, v69, v69 quad_perm:[1,0,3,2] row_mask:0xf bank_mask:0xf
    s_nop 1
    v_add_f32_dpp v69, v69, v69 quad_perm:[2,3,0,1] row_mask:0xf bank_mask:0xf
    v_max3_f32 v13, v68, v69, v13
    v_cvt_pk_bf16_f32 v69, v68, v69
    v_lshlrev_b32 v68, 16, v69
    v_and_b32 v69, 0xffff0000, v69
    v_mul_f32 v68, s22, v68
    v_mul_f32 v69, s22, v69
    v_cvt_pk_bf16_f32 v58, v68, v69
    v_dot2_f32_bf16 v9, v216, v24, 0
    v_dot2_f32_bf16 v10, v220, v24, 0
    v_dot2_f32_bf16 v11, v224, v24, 0
    v_dot2_f32_bf16 v12, v228, v24, 0
    v_dot2_f32_bf16 v9, v217, v25, v9
    v_dot2_f32_bf16 v10, v221, v25, v10
    v_dot2_f32_bf16 v11, v225, v25, v11
    v_dot2_f32_bf16 v12, v229, v25, v12
    v_dot2_f32_bf16 v9, v218, v26, v9
    v_dot2_f32_bf16 v10, v222, v26, v10
    v_dot2_f32_bf16 v11, v226, v26, v11
    v_dot2_f32_bf16 v12, v230, v26, v12
    v_dot2_f32_bf16 v9, v219, v27, v9
    v_dot2_f32_bf16 v10, v223, v27, v10
    v_dot2_f32_bf16 v11, v227, v27, v11
    v_dot2_f32_bf16 v12, v231, v27, v12
    s_mov_b32 s74, 0xe0000
    s_waitcnt vmcnt(39)
    buffer_load_dwordx4 v[216:219], v4, s[28:31], s74 offen offset:0 nt
    s_waitcnt vmcnt(39)
    buffer_load_dwordx4 v[220:223], v4, s[28:31], s74 offen offset:1024 nt
    s_waitcnt vmcnt(39)
    buffer_load_dwordx4 v[224:227], v4, s[28:31], s74 offen offset:2048 nt
    s_mov_b32 m0, s9
    s_nop 0
    s_waitcnt vmcnt(39)
    buffer_load_dwordx4 v6, s[40:43], s17 offen offset:0  lds
    s_waitcnt vmcnt(39)
    buffer_load_dwordx4 v[228:231], v4, s[28:31], s74 offen offset:3072 nt
    v_add_f32_dpp v9, v9, v9 row_ror:8 row_mask:0xf bank_mask:0x3
    v_add_f32_dpp v11, v11, v11 row_ror:8 row_mask:0xf bank_mask:0x3
    v_add_f32_dpp v9, v10, v10 row_ror:8 row_mask:0xf bank_mask:0xc
    v_add_f32_dpp v11, v12, v12 row_ror:8 row_mask:0xf bank_mask:0xc
    s_nop 0
    v_add_f32_dpp v68, v9, v9 row_half_mirror row_mask:0xf bank_mask:0x5
    v_add_f32_dpp v68, v11, v11 row_half_mirror row_mask:0xf bank_mask:0xa
    s_nop 1
    v_add_f32_dpp v68, v68, v68 quad_perm:[1,0,3,2] row_mask:0xf bank_mask:0xf
    s_nop 1
    v_add_f32_dpp v68, v68, v68 quad_perm:[2,3,0,1] row_mask:0xf bank_mask:0xf
    s_cmp_eq_u32 s85, 0
    s_cbranch_scc1 L_ffn2a
    s_mov_b32 s3, 0
L_g_chk:
    v_xor_b32 v40, s92, v40
    v_xor_b32 v41, s92, v41
    v_xor_b32 v42, s92, v42
    v_xor_b32 v43, s92, v43
    v_xor_b32 v44, s92, v44
    v_xor_b32 v45, s92, v45
    v_xor_b32 v46, s92, v46
    v_xor_b32 v47, s92, v47
    v_or3_b32 v88, v40, v41, v42
    v_or3_b32 v88, v88, v43, v44
    v_or3_b32 v88, v88, v45, v46
    v_or_b32 v88, v88, v47
    v_and_b32 v88, 0x7, v88
    v_cmp_ne_u32 vcc, 0, v88
    s_add_u32 s3, s3, 1
    s_cbranch_vccz L_g_ok
    s_cmp_ge_u32 s3, 0x40000
    s_cbranch_scc1 L_g_ok
    buffer_load_dwordx4 v[40:43], v7, s[56:59], 0 offen sc1
    buffer_load_dwordx4 v[44:47], v7, s[56:59], 0 offen offset:1024 sc1
    s_waitcnt vmcnt(0)
    s_branch L_g_chk
L_g_ok:
    v_add_f32_dpp v40, v40, v40 quad_perm:[1,0,3,2] row_mask:0xf bank_mask:0xf
    v_add_f32_dpp v41, v41, v41 quad_perm:[1,0,3,2] row_mask:0xf bank_mask:0xf
    v_add_f32_dpp v42, v42, v42 quad_perm:[1,0,3,2] row_mask:0xf bank_mask:0xf
    v_add_f32_dpp v43, v43, v43 quad_perm:[1,0,3,2] row_mask:0xf bank_mask:0xf
    v_add_f32_dpp v44, v44, v44 quad_perm:[1,0,3,2] row_mask:0xf bank_mask:0xf
    v_add_f32_dpp v45, v45, v45 quad_perm:[1,0,3,2] row_mask:0xf bank_mask:0xf
    v_add_f32_dpp v46, v46, v46 quad_perm:[1,0,3,2] row_mask:0xf bank_mask:0xf
    v_add_f32_dpp v47, v47, v47 quad_perm:[1,0,3,2] row_mask:0xf bank_mask:0xf
    v_add_f32_dpp v40, v40, v40 quad_perm:[2,3,0,1] row_mask:0xf bank_mask:0xf
    v_add_f32_dpp v41, v41, v41 quad_perm:[2,3,0,1] row_mask:0xf bank_mask:0xf
    v_add_f32_dpp v42, v42, v42 quad_perm:[2,3,0,1] row_mask:0xf bank_mask:0xf
    v_add_f32_dpp v43, v43, v43 quad_perm:[2,3,0,1] row_mask:0xf bank_mask:0xf
    v_add_f32_dpp v44, v44, v44 quad_perm:[2,3,0,1] row_mask:0xf bank_mask:0xf
    v_add_f32_dpp v45, v45, v45 quad_perm:[2,3,0,1] row_mask:0xf bank_mask:0xf
    v_add_f32_dpp v46, v46, v46 quad_perm:[2,3,0,1] row_mask:0xf bank_mask:0xf
    v_add_f32_dpp v47, v47, v47 quad_perm:[2,3,0,1] row_mask:0xf bank_mask:0xf
L_ffn2a:
    v_dot2_f32_bf16 v9, v232, v24, 0
    v_dot2_f32_bf16 v10, v236, v24, 0
    s_waitcnt vmcnt(39)
    buffer_load_dwordx4 a[24:27], v4, s[32:35], s75 offen offset:2048 nt
    v_dot2_f32_bf16 v11, v240, v24, 0
    v_dot2_f32_bf16 v12, v244, v24, 0
    v_dot2_f32_bf16 v9, v233, v25, v9
    v_dot2_f32_bf16 v10, v237, v25, v10
    v_dot2_f32_bf16 v11, v241, v25, v11
    v_dot2_f32_bf16 v12, v245, v25, v12
    v_dot2_f32_bf16 v9, v234, v26, v9
    v_dot2_f32_bf16 v10, v238, v26, v10
    v_dot2_f32_bf16 v11, v242, v26, v11
    v_dot2_f32_bf16 v12, v246, v26, v12
    v_dot2_f32_bf16 v9, v235, v27, v9
    v_dot2_f32_bf16 v10, v239, v27, v10
    v_dot2_f32_bf16 v11, v243, v27, v11
    v_dot2_f32_bf16 v12, v247, v27, v12
    s_mov_b32 s74, 0xe1000
    s_waitcnt vmcnt(39)
    buffer_load_dwordx4 v[232:235], v4, s[28:31], s74 offen offset:0 nt
    s_waitcnt vmcnt(39)
    buffer_load_dwordx4 v6, s[40:43], s17 offen offset:1024  lds
    s_waitcnt vmcnt(39)
    buffer_load_dwordx4 v[236:239], v4, s[28:31], s74 offen offset:1024 nt
    s_waitcnt vmcnt(39)
    buffer_load_dwordx4 v[240:243], v4, s[28:31], s74 offen offset:2048 nt
    s_waitcnt vmcnt(39)
    buffer_load_dwordx4 v6, s[40:43], s17 offen offset:2048  lds
    s_waitcnt vmcnt(39)
    buffer_load_dwordx4 v[244:247], v4, s[28:31], s74 offen offset:3072 nt
    v_add_f32_dpp v9, v9, v9 row_ror:8 row_mask:0xf bank_mask:0x3
    v_add_f32_dpp v11, v11, v11 row_ror:8 row_mask:0xf bank_mask:0x3
    v_add_f32_dpp v9, v10, v10 row_ror:8 row_mask:0xf bank_mask:0xc
    v_add_f32_dpp v11, v12, v12 row_ror:8 row_mask:0xf bank_mask:0xc
    s_nop 0
    v_add_f32_dpp v69, v9, v9 row_half_mirror row_mask:0xf bank_mask:0x5
    v_add_f32_dpp v69, v11, v11 row_half_mirror row_mask:0xf bank_mask:0xa
    s_nop 1
    v_add_f32_dpp v69, v69, v69 quad_perm:[1,0,3,2] row_mask:0xf bank_mask:0xf
    s_nop 1
    v_add_f32_dpp v69, v69, v69 quad_perm:[2,3,0,1] row_mask:0xf bank_mask:0xf
    v_max3_f32 v13, v68, v69, v13
    v_cvt_pk_bf16_f32 v69, v68, v69
    v_lshlrev_b32 v68, 16, v69
    v_and_b32 v69, 0xffff0000, v69
    v_mul_f32 v68, s22, v68
    v_mul_f32 v69, s22, v69
    v_cvt_pk_bf16_f32 v59, v68, v69
    s_cmp_eq_u32 s85, 0
    s_cbranch_scc1 L_ffn2b
    v_cvt_pk_bf16_f32 v48, v40, v44
    v_cvt_pk_bf16_f32 v49, v41, v45
    v_cvt_pk_bf16_f32 v50, v42, v46
    v_cvt_pk_bf16_f32 v51, v43, v47
    v_lshlrev_b32 v40, 16, v48
    v_and_b32 v44, 0xffff0000, v48
    v_lshlrev_b32 v41, 16, v49
    v_and_b32 v45, 0xffff0000, v49
    v_lshlrev_b32 v42, 16, v50
    v_and_b32 v46, 0xffff0000, v50
    v_lshlrev_b32 v43, 16, v51
    v_and_b32 v47, 0xffff0000, v51
    v_mul_f32 v48, s23, v40
    v_mul_f32 v49, s23, v41
    v_mul_f32 v50, s23, v42
    v_mul_f32 v51, s23, v43
    v_exp_f32 v48, -v48
    v_exp_f32 v49, -v49
    v_exp_f32 v50, -v50
    v_exp_f32 v51, -v51
    v_add_f32 v48, 1.0, v48
    v_add_f32 v49, 1.0, v49
    v_add_f32 v50, 1.0, v50
    v_add_f32 v51, 1.0, v51
    v_rcp_f32 v48, v48
    v_rcp_f32 v49, v49
    v_rcp_f32 v50, v50
    v_rcp_f32 v51, v51
    v_mul_f32 v40, v40, v48
    v_mul_f32 v41, v41, v49
    v_mul_f32 v42, v42, v50
    v_mul_f32 v43, v43, v51
    v_cvt_pk_bf16_f32 v48, v40, v41
    v_cvt_pk_bf16_f32 v50, v42, v43
    v_lshlrev_b32 v40, 16, v48
    v_and_b32 v41, 0xffff0000, v48
    v_lshlrev_b32 v42, 16, v50
    v_and_b32 v43, 0xffff0000, v50
    v_mul_f32 v40, v40, v44
    v_mul_f32 v41, v41, v45
    v_mul_f32 v42, v42, v46
    v_mul_f32 v43, v43, v47
    v_cvt_pk_bf16_f32 v48, v40, v41
    v_cvt_pk_bf16_f32 v49, v42, v43
    v_mov_b32 v50, v48
    v_mov_b32 v51, v49
    s_nop 0
    v_mov_b32_dpp v50, v48 row_half_mirror row_mask:0xf bank_mask:0x5
    v_mov_b32_dpp v51, v49 row_half_mirror row_mask:0xf bank_mask:0x5
    v_mov_b32_dpp v48, v48 row_half_mirror row_mask:0xf bank_mask:0xa
    v_mov_b32_dpp v49, v49 row_half_mirror row_mask:0xf bank_mask:0xa
L_ffn2b:
    v_dot2_f32_bf16 v9, v120, v24, 0
    s_waitcnt vmcnt(39)
    buffer_load_dwordx4 a[28:31], v4, s[32:35], s75 offen offset:3072 nt
    v_dot2_f32_bf16 v10, v124, v24, 0
    v_dot2_f32_bf16 v11, v128, v24, 0
    v_dot2_f32_bf16 v12, v132, v24, 0
    v_dot2_f32_bf16 v9, v121, v25, v9
    v_dot2_f32_bf16 v10, v125, v25, v10
    v_dot2_f32_bf16 v11, v129, v25, v11
    v_dot2_f32_bf16 v12, v133, v25, v12
    v_dot2_f32_bf16 v9, v122, v26, v9
    v_dot2_f32_bf16 v10, v126, v26, v10
    v_dot2_f32_bf16 v11, v130, v26, v11
    v_dot2_f32_bf16 v12, v134, v26, v12
    v_dot2_f32_bf16 v9, v123, v27, v9
    v_dot2_f32_bf16 v10, v127, v27, v10
    v_dot2_f32_bf16 v11, v131, v27, v11
    v_dot2_f32_bf16 v12, v135, v27, v12
    s_nop 1
    v_add_f32_dpp v9, v9, v9 row_ror:8 row_mask:0xf bank_mask:0x3
    v_add_f32_dpp v11, v11, v11 row_ror:8 row_mask:0xf bank_mask:0x3
    v_add_f32_dpp v9, v10, v10 row_ror:8 row_mask:0xf bank_mask:0xc
    v_add_f32_dpp v11, v12, v12 row_ror:8 row_mask:0xf bank_mask:0xc
    s_nop 0
    v_add_f32_dpp v68, v9, v9 row_half_mirror row_mask:0xf bank_mask:0x5
    v_add_f32_dpp v68, v11, v11 row_half_mirror row_mask:0xf bank_mask:0xa
    s_nop 1
    v_add_f32_dpp v68, v68, v68 quad_perm:[1,0,3,2] row_mask:0xf bank_mask:0xf
    s_nop 1
    v_add_f32_dpp v68, v68, v68 quad_perm:[2,3,0,1] row_mask:0xf bank_mask:0xf
    s_cmp_eq_u32 s85, 0
    s_cbranch_scc1 L_ffn2c
    v_perm_b32 v28, v48, v48, v16
    v_perm_b32 v29, v48, v48, v17
    v_perm_b32 v30, v48, v48, v18
    v_perm_b32 v31, v48, v48, v19
    s_nop 1
    v_mfma_f32_16x16x32_bf16 v[36:39], v[28:31], a[224:227], 0
    v_perm_b32 v32, v48, v48, v20
    v_perm_b32 v33, v48, v48, v21
    v_perm_b32 v34, v48, v48, v22
    v_perm_b32 v35, v48, v48, v23
    s_nop 1
    v_mfma_f32_16x16x32_bf16 v[36:39], v[32:35], a[228:231], v[36:39]
    v_perm_b32 v28, v49, v49, v16
    v_perm_b32 v29, v49, v49, v17
    v_perm_b32 v30, v49, v49, v18
    v_perm_b32 v31, v49, v49, v19
    s_nop 1
    v_mfma_f32_16x16x32_bf16 v[36:39], v[28:31], a[232:235], v[36:39]
    v_perm_b32 v32, v49, v49, v20
    v_perm_b32 v33, v49, v49, v21
    v_perm_b32 v34, v49, v49, v22
    v_perm_b32 v35, v49, v49, v23
    s_nop 1
    v_mfma_f32_16x16x32_bf16 v[36:39], v[32:35], a[236:239], v[36:39]
    v_perm_b32 v28, v50, v50, v16
    v_perm_b32 v29, v50, v50, v17
    v_perm_b32 v30, v50, v50, v18
    v_perm_b32 v31, v50, v50, v19
    s_nop 1
    v_mfma_f32_16x16x32_bf16 v[36:39], v[28:31], a[240:243], v[36:39]
    v_perm_b32 v32, v50, v50, v20
    v_perm_b32 v33, v50, v50, v21
    v_perm_b32 v34, v50, v50, v22
    v_perm_b32 v35, v50, v50, v23
    s_nop 1
    v_mfma_f32_16x16x32_bf16 v[36:39], v[32:35], a[244:247], v[36:39]
    v_perm_b32 v28, v51, v51, v16
    v_perm_b32 v29, v51, v51, v17
    v_perm_b32 v30, v51, v51, v18
    v_perm_b32 v31, v51, v51, v19
    s_nop 1
    v_mfma_f32_16x16x32_bf16 v[36:39], v[28:31], a[248:251], v[36:39]
    v_perm_b32 v32, v51, v51, v20
    v_perm_b32 v33, v51, v51, v21
    v_perm_b32 v34, v51, v51, v22
    v_perm_b32 v35, v51, v51, v23
    s_nop 1
    v_mfma_f32_16x16x32_bf16 v[36:39], v[32:35], a[252:255], v[36:39]
    v_lshrrev_b32 v88, 1, v3
    v_mul_u32_u24 v88, 97792, v88
    s_lshl_b32 s76, s70, 9
    s_add_u32 s76, s76, s80
    v_add3_u32 v88, v88, v14, s76
    s_nop 3
    v_mov_b32 v44, 0x3ff
    v_add_u32 v40, 0x200, v36
    v_add_u32 v41, 0x200, v37
    v_add_u32 v42, 0x200, v38
    v_add_u32 v43, 0x200, v39
    v_bfi_b32 v40, v44, s24, v40
    v_bfi_b32 v41, v44, s24, v41
    v_bfi_b32 v42, v44, s24, v42
    v_bfi_b32 v43, v44, s24, v43
    buffer_store_dwordx4 v[40:43], v88, s[52:55], 0 offen sc1
L_ffn2c:
    v_dot2_f32_bf16 v9, v136, v24, 0
    s_mov_b32 s75, 0x80000
    s_waitcnt vmcnt(39)
    buffer_load_dwordx4 a[32:35], v4, s[32:35], s75 offen offset:0 nt
    s_waitcnt vmcnt(39)
    buffer_load_dwordx4 v6, s[40:43], s17 offen offset:3072  lds
    v_dot2_f32_bf16 v10, v140, v24, 0
    s_waitcnt vmcnt(39)
    v_dot2_f32_bf16 v11, v144, v24, 0
    s_waitcnt vmcnt(37)
    v_dot2_f32_bf16 v12, v148, v24, 0
    v_dot2_f32_bf16 v9, v137, v25, v9
    v_dot2_f32_bf16 v10, v141, v25, v10
    v_dot2_f32_bf16 v11, v145, v25, v11
    v_dot2_f32_bf16 v12, v149, v25, v12
    v_dot2_f32_bf16 v9, v138, v26, v9
    v_dot2_f32_bf16 v10, v142, v26, v10
    v_dot2_f32_bf16 v11, v146, v26, v11
    v_dot2_f32_bf16 v12, v150, v26, v12
    v_dot2_f32_bf16 v9, v139, v27, v9
    v_dot2_f32_bf16 v10, v143, v27, v10
    v_dot2_f32_bf16 v11, v147, v27, v11
    v_dot2_f32_bf16 v12, v151, v27, v12
    s_nop 1
    v_add_f32_dpp v9, v9, v9 row_ror:8 row_mask:0xf bank_mask:0x3
    v_add_f32_dpp v11, v11, v11 row_ror:8 row_mask:0xf bank_mask:0x3
    v_add_f32_dpp v9, v10, v10 row_ror:8 row_mask:0xf bank_mask:0xc
    v_add_f32_dpp v11, v12, v12 row_ror:8 row_mask:0xf bank_mask:0xc
    s_nop 0
    v_add_f32_dpp v69, v9, v9 row_half_mirror row_mask:0xf bank_mask:0x5
    v_add_f32_dpp v69, v11, v11 row_half_mirror row_mask:0xf bank_mask:0xa
    s_nop 1
    v_add_f32_dpp v69, v69, v69 quad_perm:[1,0,3,2] row_mask:0xf bank_mask:0xf
    s_nop 1
    v_add_f32_dpp v69, v69, v69 quad_perm:[2,3,0,1] row_mask:0xf bank_mask:0xf
    v_max3_f32 v13, v68, v69, v13
    v_cvt_pk_bf16_f32 v69, v68, v69
    v_lshlrev_b32 v68, 16, v69
    v_and_b32 v69, 0xffff0000, v69
    v_mul_f32 v68, s22, v68
    v_mul_f32 v69, s22, v69
    v_cvt_pk_bf16_f32 v60, v68, v69
    s_waitcnt vmcnt(36)
    v_dot2_f32_bf16 v9, v152, v24, 0
    s_waitcnt vmcnt(35)
    v_dot2_f32_bf16 v10, v156, v24, 0
    s_waitcnt vmcnt(33)
    v_dot2_f32_bf16 v11, v160, v24, 0
    s_waitcnt vmcnt(32)
    v_dot2_f32_bf16 v12, v164, v24, 0
    v_dot2_f32_bf16 v9, v153, v25, v9
    v_dot2_f32_bf16 v10, v157, v25, v10
    v_dot2_f32_bf16 v11, v161, v25, v11
    v_dot2_f32_bf16 v12, v165, v25, v12
    v_dot2_f32_bf16 v9, v154, v26, v9
    v_dot2_f32_bf16 v10, v158, v26, v10
    buffer_load_dwordx4 a[36:39], v4, s[32:35], s75 offen offset:1024 nt
    v_dot2_f32_bf16 v11, v162, v26, v11
    v_dot2_f32_bf16 v12, v166, v26, v12
    v_dot2_f32_bf16 v9, v155, v27, v9
    v_dot2_f32_bf16 v10, v159, v27, v10
    v_dot2_f32_bf16 v11, v163, v27, v11
    v_dot2_f32_bf16 v12, v167, v27, v12
    s_nop 1
    v_add_f32_dpp v9, v9, v9 row_ror:8 row_mask:0xf bank_mask:0x3
    v_add_f32_dpp v11, v11, v11 row_ror:8 row_mask:0xf bank_mask:0x3
    v_add_f32_dpp v9, v10, v10 row_ror:8 row_mask:0xf bank_mask:0xc
    v_add_f32_dpp v11, v12, v12 row_ror:8 row_mask:0xf bank_mask:0xc
    s_nop 0
    v_add_f32_dpp v68, v9, v9 row_half_mirror row_mask:0xf bank_mask:0x5
    v_add_f32_dpp v68, v11, v11 row_half_mirror row_mask:0xf bank_mask:0xa
    s_nop 1
    v_add_f32_dpp v68, v68, v68 quad_perm:[1,0,3,2] row_mask:0xf bank_mask:0xf
    s_nop 1
    v_add_f32_dpp v68, v68, v68 quad_perm:[2,3,0,1] row_mask:0xf bank_mask:0xf
    s_waitcnt vmcnt(32)
    v_dot2_f32_bf16 v9, v168, v24, 0
    s_waitcnt vmcnt(30)
    v_dot2_f32_bf16 v10, v172, v24, 0
    s_waitcnt vmcnt(29)
    v_dot2_f32_bf16 v11, v176, v24, 0
    s_waitcnt vmcnt(28)
    v_dot2_f32_bf16 v12, v180, v24, 0
    v_dot2_f32_bf16 v9, v169, v25, v9
    v_dot2_f32_bf16 v10, v173, v25, v10
    v_dot2_f32_bf16 v11, v177, v25, v11
    v_dot2_f32_bf16 v12, v181, v25, v12
    v_dot2_f32_bf16 v9, v170, v26, v9
    v_dot2_f32_bf16 v10, v174, v26, v10
    v_dot2_f32_bf16 v11, v178, v26, v11
    v_dot2_f32_bf16 v12, v182, v26, v12
    v_dot2_f32_bf16 v9, v171, v27, v9
    v_dot2_f32_bf16 v10, v175, v27, v10
    v_dot2_f32_bf16 v11, v179, v27, v11
    v_dot2_f32_bf16 v12, v183, v27, v12
    s_nop 1
    v_add_f32_dpp v9, v9, v9 row_ror:8 row_mask:0xf bank_mask:0x3
    v_add_f32_dpp v11, v11, v11 row_ror:8 row_mask:0xf bank_mask:0x3
    v_add_f32_dpp v9, v10, v10 row_ror:8 row_mask:0xf bank_mask:0xc
    v_add_f32_dpp v11, v12, v12 row_ror:8 row_mask:0xf bank_mask:0xc
    s_nop 0
    v_add_f32_dpp v69, v9, v9 row_half_mirror row_mask:0xf bank_mask:0x5
    v_add_f32_dpp v69, v11, v11 row_half_mirror row_mask:0xf bank_mask:0xa
    s_nop 1
    v_add_f32_dpp v69, v69, v69 quad_perm:[1,0,3,2] row_mask:0xf bank_mask:0xf
    s_nop 1
    v_add_f32_dpp v69, v69, v69 quad_perm:[2,3,0,1] row_mask:0xf bank_mask:0xf
    buffer_load_dwordx4 a[40:43], v4, s[32:35], s75 offen offset:2048 nt
    v_max3_f32 v13, v68, v69, v13
    v_cvt_pk_bf16_f32 v69, v68, v69
    v_lshlrev_b32 v68, 16, v69
    v_and_b32 v69, 0xffff0000, v69
    v_mul_f32 v68, s22, v68
    v_mul_f32 v69, s22, v69
    v_cvt_pk_bf16_f32 v61, v68, v69
    s_waitcnt vmcnt(27)
    v_dot2_f32_bf16 v9, v184, v24, 0
    s_waitcnt vmcnt(26)
    v_dot2_f32_bf16 v10, v188, v24, 0
    s_waitcnt vmcnt(24)
    v_dot2_f32_bf16 v11, v192, v24, 0
    s_waitcnt vmcnt(23)
    v_dot2_f32_bf16 v12, v196, v24, 0
    v_dot2_f32_bf16 v9, v185, v25, v9
    v_dot2_f32_bf16 v10, v189, v25, v10
    v_dot2_f32_bf16 v11, v193, v25, v11
    v_dot2_f32_bf16 v12, v197, v25, v12
    v_dot2_f32_bf16 v9, v186, v26, v9
    v_dot2_f32_bf16 v10, v190, v26, v10
    v_dot2_f32_bf16 v11, v194, v26, v11
    v_dot2_f32_bf16 v12, v198, v26, v12
    v_dot2_f32_bf16 v9, v187, v27, v9
    v_dot2_f32_bf16 v10, v191, v27, v10
    v_dot2_f32_bf16 v11, v195, v27, v11
    v_dot2_f32_bf16 v12, v199, v27, v12
    s_nop 1
    v_add_f32_dpp v9, v9, v9 row_ror:8 row_mask:0xf bank_mask:0x3
    v_add_f32_dpp v11, v11, v11 row_ror:8 row_mask:0xf bank_mask:0x3
    v_add_f32_dpp v9, v10, v10 row_ror:8 row_mask:0xf bank_mask:0xc
    v_add_f32_dpp v11, v12, v12 row_ror:8 row_mask:0xf bank_mask:0xc
    s_nop 0
    v_add_f32_dpp v68, v9, v9 row_half_mirror row_mask:0xf bank_mask:0x5
    v_add_f32_dpp v68, v11, v11 row_half_mirror row_mask:0xf bank_mask:0xa
    s_nop 1
    v_add_f32_dpp v68, v68, v68 quad_perm:[1,0,3,2] row_mask:0xf bank_mask:0xf
    s_nop 1
    v_add_f32_dpp v68, v68, v68 quad_perm:[2,3,0,1] row_mask:0xf bank_mask:0xf
    s_waitcnt vmcnt(22)
    v_dot2_f32_bf16 v9, v200, v24, 0
    s_waitcnt vmcnt(20)
    v_dot2_f32_bf16 v10, v204, v24, 0
    s_waitcnt vmcnt(19)
    v_dot2_f32_bf16 v11, v208, v24, 0
    s_waitcnt vmcnt(18)
    v_dot2_f32_bf16 v12, v212, v24, 0
    v_dot2_f32_bf16 v9, v201, v25, v9
    v_dot2_f32_bf16 v10, v205, v25, v10
    v_dot2_f32_bf16 v11, v209, v25, v11
    v_dot2_f32_bf16 v12, v213, v25, v12
    v_dot2_f32_bf16 v9, v202, v26, v9
    buffer_load_dwordx4 a[44:47], v4, s[32:35], s75 offen offset:3072 nt
    s_mov_b32 m0, s10
    s_nop 0
    buffer_load_dwordx4 v6, s[40:43], s18 offen offset:0  lds
    v_dot2_f32_bf16 v10, v206, v26, v10
    v_dot2_f32_bf16 v11, v210, v26, v11
    v_dot2_f32_bf16 v12, v214, v26, v12
    v_dot2_f32_bf16 v9, v203, v27, v9
    v_dot2_f32_bf16 v10, v207, v27, v10
    v_dot2_f32_bf16 v11, v211, v27, v11
    v_dot2_f32_bf16 v12, v215, v27, v12
    s_nop 1
    v_add_f32_dpp v9, v9, v9 row_ror:8 row_mask:0xf bank_mask:0x3
    v_add_f32_dpp v11, v11, v11 row_ror:8 row_mask:0xf bank_mask:0x3
    v_add_f32_dpp v9, v10, v10 row_ror:8 row_mask:0xf bank_mask:0xc
    v_add_f32_dpp v11, v12, v12 row_ror:8 row_mask:0xf bank_mask:0xc
    s_nop 0
    v_add_f32_dpp v69, v9, v9 row_half_mirror row_mask:0xf bank_mask:0x5
    v_add_f32_dpp v69, v11, v11 row_half_mirror row_mask:0xf bank_mask:0xa
    s_nop 1
    v_add_f32_dpp v69, v69, v69 quad_perm:[1,0,3,2] row_mask:0xf bank_mask:0xf
    s_nop 1
    v_add_f32_dpp v69, v69, v69 quad_perm:[2,3,0,1] row_mask:0xf bank_mask:0xf
    v_max3_f32 v13, v68, v69, v13
    v_cvt_pk_bf16_f32 v69, v68, v69
    v_lshlrev_b32 v68, 16, v69
    v_and_b32 v69, 0xffff0000, v69
    v_mul_f32 v68, s22, v68
    v_mul_f32 v69, s22, v69
    v_cvt_pk_bf16_f32 v62, v68, v69
    s_waitcnt vmcnt(18)
    v_dot2_f32_bf16 v9, v216, v24, 0
    s_waitcnt vmcnt(17)
    v_dot2_f32_bf16 v10, v220, v24, 0
    s_waitcnt vmcnt(16)
    v_dot2_f32_bf16 v11, v224, v24, 0
    s_waitcnt vmcnt(14)
    v_dot2_f32_bf16 v12, v228, v24, 0
    v_dot2_f32_bf16 v9, v217, v25, v9
    v_dot2_f32_bf16 v10, v221, v25, v10
    v_dot2_f32_bf16 v11, v225, v25, v11
    v_dot2_f32_bf16 v12, v229, v25, v12
    v_dot2_f32_bf16 v9, v218, v26, v9
    v_dot2_f32_bf16 v10, v222, v26, v10
    v_dot2_f32_bf16 v11, v226, v26, v11
    v_dot2_f32_bf16 v12, v230, v26, v12
    v_dot2_f32_bf16 v9, v219, v27, v9
    v_dot2_f32_bf16 v10, v223, v27, v10
    v_dot2_f32_bf16 v11, v227, v27, v11
    v_dot2_f32_bf16 v12, v231, v27, v12
    s_nop 1
    v_add_f32_dpp v9, v9, v9 row_ror:8 row_mask:0xf bank_mask:0x3
    v_add_f32_dpp v11, v11, v11 row_ror:8 row_mask:0xf bank_mask:0x3
    s_mov_b32 s75, 0x81000
    buffer_load_dwordx4 a[48:51], v4, s[32:35], s75 offen offset:0 nt
    v_add_f32_dpp v9, v10, v10 row_ror:8 row_mask:0xf bank_mask:0xc
    v_add_f32_dpp v11, v12, v12 row_ror:8 row_mask:0xf bank_mask:0xc
    s_nop 0
    v_add_f32_dpp v68, v9, v9 row_half_mirror row_mask:0xf bank_mask:0x5
    v_add_f32_dpp v68, v11, v11 row_half_mirror row_mask:0xf bank_mask:0xa
    s_nop 1
    v_add_f32_dpp v68, v68, v68 quad_perm:[1,0,3,2] row_mask:0xf bank_mask:0xf
    s_nop 1
    v_add_f32_dpp v68, v68, v68 quad_perm:[2,3,0,1] row_mask:0xf bank_mask:0xf
    s_waitcnt vmcnt(13)
    v_dot2_f32_bf16 v9, v232, v24, 0
    s_waitcnt vmcnt(11)
    v_dot2_f32_bf16 v10, v236, v24, 0
    buffer_load_dwordx4 a[52:55], v4, s[32:35], s75 offen offset:1024 nt
    s_waitcnt vmcnt(11)
    v_dot2_f32_bf16 v11, v240, v24, 0
    buffer_load_dwordx4 a[56:59], v4, s[32:35], s75 offen offset:2048 nt
    buffer_load_dwordx4 v6, s[40:43], s18 offen offset:1024  lds
    s_waitcnt vmcnt(11)
    v_dot2_f32_bf16 v12, v244, v24, 0
    v_dot2_f32_bf16 v9, v233, v25, v9
    v_dot2_f32_bf16 v10, v237, v25, v10
    v_dot2_f32_bf16 v11, v241, v25, v11
    v_dot2_f32_bf16 v12, v245, v25, v12
    v_dot2_f32_bf16 v9, v234, v26, v9
    v_dot2_f32_bf16 v10, v238, v26, v10
    v_dot2_f32_bf16 v11, v242, v26, v11
    v_dot2_f32_bf16 v12, v246, v26, v12
    v_dot2_f32_bf16 v9, v235, v27, v9
    v_dot2_f32_bf16 v10, v239, v27, v10
    v_dot2_f32_bf16 v11, v243, v27, v11
    v_dot2_f32_bf16 v12, v247, v27, v12
    s_nop 1
    v_add_f32_dpp v9, v9, v9 row_ror:8 row_mask:0xf bank_mask:0x3
    v_add_f32_dpp v11, v11, v11 row_ror:8 row_mask:0xf bank_mask:0x3
    v_add_f32_dpp v9, v10, v10 row_ror:8 row_mask:0xf bank_mask:0xc
    v_add_f32_dpp v11, v12, v12 row_ror:8 row_mask:0xf bank_mask:0xc
    s_nop 0
    v_add_f32_dpp v69, v9, v9 row_half_mirror row_mask:0xf bank_mask:0x5
    v_add_f32_dpp v69, v11, v11 row_half_mirror row_mask:0xf bank_mask:0xa
    s_nop 1
    v_add_f32_dpp v69, v69, v69 quad_perm:[1,0,3,2] row_mask:0xf bank_mask:0xf
    s_nop 1
    v_add_f32_dpp v69, v69, v69 quad_perm:[2,3,0,1] row_mask:0xf bank_mask:0xf
    v_max3_f32 v13, v68, v69, v13
    v_cvt_pk_bf16_f32 v69, v68, v69
    v_lshlrev_b32 v68, 16, v69
    v_and_b32 v69, 0xffff0000, v69
    v_mul_f32 v68, s22, v68
    v_mul_f32 v69, s22, v69
    v_cvt_pk_bf16_f32 v63, v68, v69
    s_lshl_b32 s76, s70, 4
    v_max_f32_dpp v13, v13, v13 row_ror:4 row_mask:0xf bank_mask:0xf
    v_lshl_add_u32 v248, v3, 2, s76
    v_mov_b32 v249, 0
    v_max_f32_dpp v13, v13, v13 row_ror:8 row_mask:0xf bank_mask:0xf
    ds_write_b32 v248, v13 offset:22528
    s_waitcnt lgkmcnt(0)
    buffer_load_dwordx4 a[60:63], v4, s[32:35], s75 offen offset:3072 nt
    s_barrier
    ds_read_b128 v[88:91], v249 offset:22528
    ds_read_b128 v[92:95], v249 offset:22544
    ds_read_b128 v[96:99], v249 offset:22560
    ds_read_b128 v[100:103], v249 offset:22576
    s_waitcnt lgkmcnt(0)
    v_max3_f32 v13, v88, v89, v90
    v_max3_f32 v13, v13, v91, v92
    v_max3_f32 v13, v13, v93, v94
    v_max3_f32 v13, v13, v95, v96
    v_max3_f32 v13, v13, v97, v98
    v_max3_f32 v13, v13, v99, v100
    v_max3_f32 v13, v13, v101, v102
    v_max_f32 v13, v13, v103
    v_cvt_pk_bf16_f32 v13, v13, v13
    v_lshlrev_b32 v13, 16, v13
    v_mul_f32 v13, s22, v13
    v_cvt_pk_bf16_f32 v13, v13, v13
    v_lshlrev_b32 v250, 16, v13
    v_mul_f32 v13, s23, v250
    v_lshlrev_b32 v88, 16, v56
    v_and_b32 v89, 0xffff0000, v56
    s_mov_b32 s75, 0x40000
    buffer_load_dwordx4 a[64:67], v4, s[32:35], s75 offen offset:0 nt
    buffer_load_dwordx4 v6, s[40:43], s18 offen offset:2048  lds
    v_lshlrev_b32 v90, 16, v57
    v_and_b32 v91, 0xffff0000, v57
    v_lshlrev_b32 v92, 16, v58
    v_and_b32 v93, 0xffff0000, v58
    v_lshlrev_b32 v94, 16, v59
    v_and_b32 v95, 0xffff0000, v59
    v_lshlrev_b32 v96, 16, v60
    v_and_b32 v97, 0xffff0000, v60
    v_lshlrev_b32 v98, 16, v61
    v_and_b32 v99, 0xffff0000, v61
    v_lshlrev_b32 v100, 16, v62
    v_and_b32 v101, 0xffff0000, v62
    v_lshlrev_b32 v102, 16, v63
    v_and_b32 v103, 0xffff0000, v63
    v_fma_f32 v88, v88, s23, -v13
    v_fma_f32 v89, v89, s23, -v13
    v_fma_f32 v90, v90, s23, -v13
    v_fma_f32 v91, v91, s23, -v13
    v_fma_f32 v92, v92, s23, -v13
    v_fma_f32 v93, v93, s23, -v13
    v_fma_f32 v94, v94, s23, -v13
    v_fma_f32 v95, v95, s23, -v13
    v_fma_f32 v96, v96, s23, -v13
    v_fma_f32 v97, v97, s23, -v13
    v_fma_f32 v98, v98, s23, -v13
    v_fma_f32 v99, v99, s23, -v13
    v_fma_f32 v100, v100, s23, -v13
    v_fma_f32 v101, v101, s23, -v13
    v_fma_f32 v102, v102, s23, -v13
    v_fma_f32 v103, v103, s23, -v13
    v_exp_f32 v88, v88
    v_exp_f32 v89, v89
    v_exp_f32 v90, v90
    v_exp_f32 v91, v91
    v_exp_f32 v92, v92
    v_exp_f32 v93, v93
    v_exp_f32 v94, v94
    v_exp_f32 v95, v95
    v_exp_f32 v96, v96
    v_exp_f32 v97, v97
    v_exp_f32 v98, v98
    v_exp_f32 v99, v99
    v_exp_f32 v100, v100
    v_exp_f32 v101, v101
    buffer_load_dwordx4 a[68:71], v4, s[32:35], s75 offen offset:1024 nt
    v_exp_f32 v102, v102
    v_exp_f32 v103, v103
    v_cvt_pk_bf16_f32 v56, v88, v89
    v_cvt_pk_bf16_f32 v57, v90, v91
    v_cvt_pk_bf16_f32 v58, v92, v93
    v_cvt_pk_bf16_f32 v59, v94, v95
    v_cvt_pk_bf16_f32 v60, v96, v97
    v_cvt_pk_bf16_f32 v61, v98, v99
    v_cvt_pk_bf16_f32 v62, v100, v101
    v_cvt_pk_bf16_f32 v63, v102, v103
    v_add_f32 v88, v88, v96
    v_add_f32 v89, v89, v97
    v_add_f32 v90, v90, v98
    v_add_f32 v91, v91, v99
    v_add_f32 v92, v92, v100
    v_add_f32 v93, v93, v101
    v_add_f32 v94, v94, v102
    v_add_f32 v95, v95, v103
    v_add_f32 v88, v88, v92
    v_add_f32 v89, v89, v93
    v_add_f32 v90, v90, v94
    v_add_f32 v91, v91, v95
    v_add_f32 v88, v88, v90
    v_add_f32 v89, v89, v91
    v_add_f32 v88, v88, v89
    v_mov_b32 v36, 0
    v_mov_b32 v37, 0
    v_mov_b32 v38, 0
    v_mov_b32 v39, 0
    v_add_f32_dpp v88, v88, v88 row_ror:4 row_mask:0xf bank_mask:0xf
    v_lshlrev_b32 v14, 4, v1
    v_add_u32 v14, s83, v14
    v_add_f32_dpp v88, v88, v88 row_ror:8 row_mask:0xf bank_mask:0xf
    ds_write_b32 v248, v88 offset:22592
    s_waitcnt lgkmcnt(0)
    s_barrier
    buffer_load_dwordx4 a[72:75], v4, s[32:35], s75 offen offset:2048 nt
    s_cmp_lg_u32 s70, 3
    s_cbranch_scc1 L_ml_done
    ds_read_b128 v[88:91], v249 offset:22592
    ds_read_b128 v[92:95], v249 offset:22608
    ds_read_b128 v[96:99], v249 offset:22624
    ds_read_b128 v[100:103], v249 offset:22640
    s_lshl_b32 s76, s73, 4
    s_add_u32 s76, s76, 0x100000
    v_mov_b32 v10, s76
    s_waitcnt lgkmcnt(0)
    v_add_f32 v88, v88, v96
    v_add_f32 v89, v89, v97
    v_add_f32 v90, v90, v98
    v_add_f32 v91, v91, v99
    v_add_f32 v92, v92, v100
    v_add_f32 v93, v93, v101
    v_add_f32 v94, v94, v102
    v_add_f32 v95, v95, v103
    v_add_f32 v88, v88, v92
    v_add_f32 v89, v89, v93
    v_add_f32 v90, v90, v94
    v_add_f32 v91, v91, v95
    v_add_f32 v88, v88, v90
    v_add_f32 v89, v89, v91
    v_add_f32 v88, v88, v89
    v_mov_b32 v89, 0x3ff
    v_add_u32 v93, 0x200, v88
    v_bfi_b32 v93, v89, s24, v93
    v_or_b32 v92, s24, v250
    v_mov_b32 v94, s24
    v_mov_b32 v95, s24
    s_mov_b64 exec, 1
    buffer_store_dwordx4 v[92:95], v10, s[52:55], 0 offen sc1
    s_mov_b64 exec, -1
L_ml_done:
    v_mov_b32_dpp v64, v56 row_newbcast:0 row_mask:0xf bank_mask:0xf
    buffer_load_dwordx4 a[76:79], v4, s[32:35], s75 offen offset:3072 nt
    buffer_load_dwordx4 v6, s[40:43], s18 offen offset:3072  lds
    v_perm_b32 v28, v64, v64, v16
    v_perm_b32 v29, v64, v64, v17
    v_perm_b32 v30, v64, v64, v18
    v_perm_b32 v31, v64, v64, v19
    v_mov_b32_dpp v65, v56 row_newbcast:8 row_mask:0xf bank_mask:0xf
    v_perm_b32 v32, v65, v65, v16
    v_perm_b32 v33, v65, v65, v17
    v_perm_b32 v34, v65, v65, v18
    v_perm_b32 v35, v65, v65, v19
    v_mfma_f32_16x16x32_bf16 v[36:39], v[28:31], a[0:3], v[36:39]
    v_mov_b32_dpp v66, v56 row_newbcast:4 row_mask:0xf bank_mask:0xf
    v_perm_b32 v28, v66, v66, v16
    v_perm_b32 v29, v66, v66, v17
    v_perm_b32 v30, v66, v66, v18
    v_perm_b32 v31, v66, v66, v19
    v_mfma_f32_16x16x32_bf16 v[36:39], v[32:35], a[4:7], v[36:39]
    v_mov_b32_dpp v67, v56 row_newbcast:12 row_mask:0xf bank_mask:0xf
    v_perm_b32 v32, v67, v67, v16
    v_perm_b32 v33, v67, v67, v17
    v_perm_b32 v34, v67, v67, v18
    v_perm_b32 v35, v67, v67, v19
    v_mfma_f32_16x16x32_bf16 v[36:39], v[28:31], a[8:11], v[36:39]
    v_perm_b32 v28, v64, v64, v20
    v_perm_b32 v29, v64, v64, v21
    v_perm_b32 v30, v64, v64, v22
    v_perm_b32 v31, v64, v64, v23
    v_mfma_f32_16x16x32_bf16 v[36:39], v[32:35], a[12:15], v[36:39]
    v_perm_b32 v32, v65, v65, v20
    v_perm_b32 v33, v65, v65, v21
    v_perm_b32 v34, v65, v65, v22
    v_perm_b32 v35, v65, v65, v23
    v_mfma_f32_16x16x32_bf16 v[36:39], v[28:31], a[16:19], v[36:39]
    v_perm_b32 v28, v66, v66, v20
    v_perm_b32 v29, v66, v66, v21
    v_perm_b32 v30, v66, v66, v22
    v_perm_b32 v31, v66, v66, v23
    v_mfma_f32_16x16x32_bf16 v[36:39], v[32:35], a[20:23], v[36:39]
    v_perm_b32 v32, v67, v67, v20
    s_mov_b32 s75, 0x41000
    buffer_load_dwordx4 a[80:83], v4, s[32:35], s75 offen offset:0 nt
    v_perm_b32 v33, v67, v67, v21
    v_perm_b32 v34, v67, v67, v22
    v_perm_b32 v35, v67, v67, v23
    v_mfma_f32_16x16x32_bf16 v[36:39], v[28:31], a[24:27], v[36:39]
    v_mov_b32_dpp v64, v57 row_newbcast:0 row_mask:0xf bank_mask:0xf
    v_perm_b32 v28, v64, v64, v16
    v_perm_b32 v29, v64, v64, v17
    v_perm_b32 v30, v64, v64, v18
    v_perm_b32 v31, v64, v64, v19
    s_waitcnt vmcnt(18)
    v_mfma_f32_16x16x32_bf16 v[36:39], v[32:35], a[28:31], v[36:39]
    v_mov_b32_dpp v65, v57 row_newbcast:8 row_mask:0xf bank_mask:0xf
    v_perm_b32 v32, v65, v65, v16
    v_perm_b32 v33, v65, v65, v17
    v_perm_b32 v34, v65, v65, v18
    v_perm_b32 v35, v65, v65, v19
    s_waitcnt vmcnt(17)
    v_mfma_f32_16x16x32_bf16 v[36:39], v[28:31], a[32:35], v[36:39]
    v_mov_b32_dpp v66, v57 row_newbcast:4 row_mask:0xf bank_mask:0xf
    v_perm_b32 v28, v66, v66, v16
    v_perm_b32 v29, v66, v66, v17
    v_perm_b32 v30, v66, v66, v18
    v_perm_b32 v31, v66, v66, v19
    s_waitcnt vmcnt(15)
    v_mfma_f32_16x16x32_bf16 v[36:39], v[32:35], a[36:39], v[36:39]
    v_mov_b32_dpp v67, v57 row_newbcast:12 row_mask:0xf bank_mask:0xf
    v_perm_b32 v32, v67, v67, v16
    v_perm_b32 v33, v67, v67, v17
    v_perm_b32 v34, v67, v67, v18
    v_perm_b32 v35, v67, v67, v19
    s_waitcnt vmcnt(14)
    v_mfma_f32_16x16x32_bf16 v[36:39], v[28:31], a[40:43], v[36:39]
    v_perm_b32 v28, v64, v64, v20
    v_perm_b32 v29, v64, v64, v21
    v_perm_b32 v30, v64, v64, v22
    v_perm_b32 v31, v64, v64, v23
    s_waitcnt vmcnt(13)
    v_mfma_f32_16x16x32_bf16 v[36:39], v[32:35], a[44:47], v[36:39]
    v_perm_b32 v32, v65, v65, v20
    v_perm_b32 v33, v65, v65, v21
    buffer_load_dwordx4 a[84:87], v4, s[32:35], s75 offen offset:1024 nt
    v_perm_b32 v34, v65, v65, v22
    v_perm_b32 v35, v65, v65, v23
    s_waitcnt vmcnt(12)
    v_mfma_f32_16x16x32_bf16 v[36:39], v[28:31], a[48:51], v[36:39]
    v_perm_b32 v28, v66, v66, v20
    v_perm_b32 v29, v66, v66, v21
    v_perm_b32 v30, v66, v66, v22
    v_perm_b32 v31, v66, v66, v23
    s_waitcnt vmcnt(11)
    v_mfma_f32_16x16x32_bf16 v[36:39], v[32:35], a[52:55], v[36:39]
    v_perm_b32 v32, v67, v67, v20
    v_perm_b32 v33, v67, v67, v21
    v_perm_b32 v34, v67, v67, v22
    v_perm_b32 v35, v67, v67, v23
    buffer_load_dwordx4 a[88:91], v4, s[32:35], s75 offen offset:2048 nt
    s_mov_b32 m0, s11
    s_nop 0
    buffer_load_dwordx4 v6, s[40:43], s19 offen offset:0  lds
    s_waitcnt vmcnt(12)
    v_mfma_f32_16x16x32_bf16 v[36:39], v[28:31], a[56:59], v[36:39]
    v_mov_b32_dpp v64, v58 row_newbcast:0 row_mask:0xf bank_mask:0xf
    v_perm_b32 v28, v64, v64, v16
    v_perm_b32 v29, v64, v64, v17
    v_perm_b32 v30, v64, v64, v18
    v_perm_b32 v31, v64, v64, v19
    buffer_load_dwordx4 a[92:95], v4, s[32:35], s75 offen offset:3072 nt
    s_waitcnt vmcnt(11)
    v_mfma_f32_16x16x32_bf16 v[36:39], v[32:35], a[60:63], v[36:39]
    v_mov_b32_dpp v65, v58 row_newbcast:8 row_mask:0xf bank_mask:0xf
    v_perm_b32 v32, v65, v65, v16
    v_perm_b32 v33, v65, v65, v17
    v_perm_b32 v34, v65, v65, v18
    v_perm_b32 v35, v65, v65, v19
    s_mov_b32 s75, 0xc0000
    buffer_load_dwordx4 a[96:99], v4, s[32:35], s75 offen offset:0 nt
    s_waitcnt vmcnt(11)
    v_mfma_f32_16x16x32_bf16 v[36:39], v[28:31], a[64:67], v[36:39]
    v_mov_b32_dpp v66, v58 row_newbcast:4 row_mask:0xf bank_mask:0xf
    v_perm_b32 v28, v66, v66, v16
    v_perm_b32 v29, v66, v66, v17
    v_perm_b32 v30, v66, v66, v18
    v_perm_b32 v31, v66, v66, v19
    buffer_load_dwordx4 a[100:103], v4, s[32:35], s75 offen offset:1024 nt
    buffer_load_dwordx4 v6, s[40:43], s19 offen offset:1024  lds
    s_waitcnt vmcnt(11)
    v_mfma_f32_16x16x32_bf16 v[36:39], v[32:35], a[68:71], v[36:39]
    v_mov_b32_dpp v67, v58 row_newbcast:12 row_mask:0xf bank_mask:0xf
    v_perm_b32 v32, v67, v67, v16
    v_perm_b32 v33, v67, v67, v17
    v_perm_b32 v34, v67, v67, v18
    v_perm_b32 v35, v67, v67, v19
    buffer_load_dwordx4 a[104:107], v4, s[32:35], s75 offen offset:2048 nt
    s_waitcnt vmcnt(11)
    v_mfma_f32_16x16x32_bf16 v[36:39], v[28:31], a[72:75], v[36:39]
    v_perm_b32 v28, v64, v64, v20
    v_perm_b32 v29, v64, v64, v21
    v_perm_b32 v30, v64, v64, v22
    v_perm_b32 v31, v64, v64, v23
    buffer_load_dwordx4 a[108:111], v4, s[32:35], s75 offen offset:3072 nt
    s_waitcnt vmcnt(11)
    v_mfma_f32_16x16x32_bf16 v[36:39], v[32:35], a[76:79], v[36:39]
    v_perm_b32 v32, v65, v65, v20
    v_perm_b32 v33, v65, v65, v21
    v_perm_b32 v34, v65, v65, v22
    v_perm_b32 v35, v65, v65, v23
    s_mov_b32 s75, 0xc1000
    buffer_load_dwordx4 a[112:115], v4, s[32:35], s75 offen offset:0 nt
    buffer_load_dwordx4 v6, s[40:43], s19 offen offset:2048  lds
    s_waitcnt vmcnt(11)
    v_mfma_f32_16x16x32_bf16 v[36:39], v[28:31], a[80:83], v[36:39]
    v_perm_b32 v28, v66, v66, v20
    v_perm_b32 v29, v66, v66, v21
    v_perm_b32 v30, v66, v66, v22
    v_perm_b32 v31, v66, v66, v23
    buffer_load_dwordx4 a[116:119], v4, s[32:35], s75 offen offset:1024 nt
    s_waitcnt vmcnt(11)
    v_mfma_f32_16x16x32_bf16 v[36:39], v[32:35], a[84:87], v[36:39]
    v_perm_b32 v32, v67, v67, v20
    v_perm_b32 v33, v67, v67, v21
    v_perm_b32 v34, v67, v67, v22
    v_perm_b32 v35, v67, v67, v23
    buffer_load_dwordx4 a[120:123], v4, s[32:35], s75 offen offset:2048 nt
    buffer_load_dwordx4 v6, s[40:43], s19 offen offset:3072  lds
    s_waitcnt vmcnt(12)
    v_mfma_f32_16x16x32_bf16 v[36:39], v[28:31], a[88:91], v[36:39]
    v_mov_b32_dpp v64, v59 row_newbcast:0 row_mask:0xf bank_mask:0xf
    v_perm_b32 v28, v64, v64, v16
    v_perm_b32 v29, v64, v64, v17
    v_perm_b32 v30, v64, v64, v18
    v_perm_b32 v31, v64, v64, v19
    buffer_load_dwordx4 a[124:127], v4, s[32:35], s75 offen offset:3072 nt
    s_waitcnt vmcnt(11)
    v_mfma_f32_16x16x32_bf16 v[36:39], v[32:35], a[92:95], v[36:39]
    v_mov_b32_dpp v65, v59 row_newbcast:8 row_mask:0xf bank_mask:0xf
    v_perm_b32 v32, v65, v65, v16
    v_perm_b32 v33, v65, v65, v17
    v_perm_b32 v34, v65, v65, v18
    v_perm_b32 v35, v65, v65, v19
    s_mov_b32 s75, 0x20000
    buffer_load_dwordx4 a[128:131], v4, s[32:35], s75 offen offset:0 nt
    s_waitcnt vmcnt(11)
    v_mfma_f32_16x16x32_bf16 v[36:39], v[28:31], a[96:99], v[36:39]
    v_lshrrev_b32 v9, 3, v0
    v_and_b32 v10, 7, v0
    s_lshl_b32 s76, s82, 7
    v_lshl_add_u32 v10, v10, 4, s76
    v_lshl_add_u32 v10, v9, 11, v10
    s_lshl_b32 s76, s81, 18
    v_add_u32 v24, s76, v10
    s_mul_i32 s76, s81, 0x18000
    s_add_u32 s76, s76, 0x80000
    v_add_u32 v10, s76, v10
    v_add_u32 v11, 0x10000, v10
    v_cmp_gt_u32 vcc, 14, v9
    s_lshl_b32 s76, s81, 11
    s_add_u32 s76, s76, 0x100000
    v_lshl_add_u32 v27, v9, 4, s76
    v_cndmask_b32 v11, v10, v11, vcc
    buffer_load_dwordx4 v[248:251], v10, s[60:63], 0 offen sc1
    buffer_load_dwordx4 v[252:255], v11, s[60:63], 0 offen sc1
    s_lshl_b32 s77, s81, 10
    s_lshl_b32 s78, s82, 6
    s_add_u32 s77, s77, s78
    v_lshl_add_u32 v25, v1, 1, s77
    buffer_load_ushort v26, v25, s[48:51], 0 offen
    v_mov_b32_dpp v66, v59 row_newbcast:4 row_mask:0xf bank_mask:0xf
    v_perm_b32 v28, v66, v66, v16
    v_perm_b32 v29, v66, v66, v17
    v_perm_b32 v30, v66, v66, v18
    v_perm_b32 v31, v66, v66, v19
    s_waitcnt vmcnt(13)
    v_mfma_f32_16x16x32_bf16 v[36:39], v[32:35], a[100:103], v[36:39]
    v_mov_b32_dpp v67, v59 row_newbcast:12 row_mask:0xf bank_mask:0xf
    v_perm_b32 v32, v67, v67, v16
    v_perm_b32 v33, v67, v67, v17
    v_perm_b32 v34, v67, v67, v18
    v_perm_b32 v35, v67, v67, v19
    s_waitcnt vmcnt(11)
    v_mfma_f32_16x16x32_bf16 v[36:39], v[28:31], a[104:107], v[36:39]
    v_perm_b32 v28, v64, v64, v20
    v_perm_b32 v29, v64, v64, v21
    v_perm_b32 v30, v64, v64, v22
    v_perm_b32 v31, v64, v64, v23
    buffer_load_dwordx4 a[132:135], v4, s[32:35], s75 offen offset:1024 nt
    s_waitcnt vmcnt(11)
    v_mfma_f32_16x16x32_bf16 v[36:39], v[32:35], a[108:111], v[36:39]
    v_perm_b32 v32, v65, v65, v20
    v_perm_b32 v33, v65, v65, v21
    v_perm_b32 v34, v65, v65, v22
    v_perm_b32 v35, v65, v65, v23
    buffer_load_dwordx4 a[136:139], v4, s[32:35], s75 offen offset:2048 nt
    s_waitcnt vmcnt(11)
    v_mfma_f32_16x16x32_bf16 v[36:39], v[28:31], a[112:115], v[36:39]
    v_perm_b32 v28, v66, v66, v20
    v_perm_b32 v29, v66, v66, v21
    v_perm_b32 v30, v66, v66, v22
    v_perm_b32 v31, v66, v66, v23
    buffer_load_dwordx4 a[140:143], v4, s[32:35], s75 offen offset:3072 nt
    s_mov_b32 s75, 0x21000
    buffer_load_dwordx4 a[144:147], v4, s[32:35], s75 offen offset:0 nt
    s_waitcnt vmcnt(11)
    v_mfma_f32_16x16x32_bf16 v[36:39], v[32:35], a[116:119], v[36:39]
    v_perm_b32 v32, v67, v67, v20
    v_perm_b32 v33, v67, v67, v21
    v_perm_b32 v34, v67, v67, v22
    v_perm_b32 v35, v67, v67, v23
    buffer_load_dwordx4 a[148:151], v4, s[32:35], s75 offen offset:1024 nt
    s_waitcnt vmcnt(11)
    v_mfma_f32_16x16x32_bf16 v[36:39], v[28:31], a[120:123], v[36:39]
    v_mov_b32_dpp v64, v60 row_newbcast:0 row_mask:0xf bank_mask:0xf
    v_perm_b32 v28, v64, v64, v16
    v_perm_b32 v29, v64, v64, v17
    v_perm_b32 v30, v64, v64, v18
    v_perm_b32 v31, v64, v64, v19
    buffer_load_dwordx4 a[152:155], v4, s[32:35], s75 offen offset:2048 nt
    buffer_load_dwordx4 a[156:159], v4, s[32:35], s75 offen offset:3072 nt
    s_waitcnt vmcnt(11)
    v_mfma_f32_16x16x32_bf16 v[36:39], v[32:35], a[124:127], v[36:39]
    ds_read_b128 v[88:91], v14 offset:0
    ds_read_b128 v[92:95], v14 offset:1024
    ds_read_b128 v[96:99], v14 offset:2048
    ds_read_b128 v[100:103], v14 offset:3072
    ds_read_b128 v[104:107], v14 offset:4096
    ds_read_b128 v[108:111], v14 offset:5120
    ds_read_b128 v[112:115], v14 offset:6144
    ds_read_b128 v[116:119], v14 offset:7168
    s_waitcnt lgkmcnt(0)
    v_perm_b32 v120, v92, v88, s20
    v_perm_b32 v121, v100, v96, s20
    v_perm_b32 v122, v108, v104, s20
    v_perm_b32 v123, v116, v112, s20
    v_perm_b32 v128, v92, v88, s21
    v_perm_b32 v129, v100, v96, s21
    v_perm_b32 v130, v108, v104, s21
    v_perm_b32 v131, v116, v112, s21
    v_perm_b32 v136, v93, v89, s20
    v_perm_b32 v137, v101, v97, s20
    v_perm_b32 v138, v109, v105, s20
    s_mov_b32 s75, 0xa0000
    buffer_load_dwordx4 a[160:163], v4, s[32:35], s75 offen offset:0 nt
    v_perm_b32 v139, v117, v113, s20
    v_perm_b32 v144, v93, v89, s21
    v_perm_b32 v145, v101, v97, s21
    v_perm_b32 v146, v109, v105, s21
    v_perm_b32 v147, v117, v113, s21
    v_perm_b32 v152, v94, v90, s20
    v_perm_b32 v153, v102, v98, s20
    v_perm_b32 v154, v110, v106, s20
    v_perm_b32 v155, v118, v114, s20
    v_perm_b32 v160, v94, v90, s21
    v_perm_b32 v161, v102, v98, s21
    v_perm_b32 v162, v110, v106, s21
    v_perm_b32 v163, v118, v114, s21
    v_perm_b32 v168, v95, v91, s20
    v_perm_b32 v169, v103, v99, s20
    v_perm_b32 v170, v111, v107, s20
    v_perm_b32 v171, v119, v115, s20
    v_perm_b32 v176, v95, v91, s21
    v_perm_b32 v177, v103, v99, s21
    v_perm_b32 v178, v111, v107, s21
    v_perm_b32 v179, v119, v115, s21
    v_mov_b32_dpp v65, v60 row_newbcast:8 row_mask:0xf bank_mask:0xf
    v_perm_b32 v32, v65, v65, v16
    v_perm_b32 v33, v65, v65, v17
    v_perm_b32 v34, v65, v65, v18
    v_perm_b32 v35, v65, v65, v19
    s_waitcnt vmcnt(11)
    v_mfma_f32_16x16x32_bf16 v[36:39], v[28:31], a[128:131], v[36:39]
    v_mov_b32_dpp v66, v60 row_newbcast:4 row_mask:0xf bank_mask:0xf
    v_perm_b32 v28, v66, v66, v16
    v_perm_b32 v29, v66, v66, v17
    v_perm_b32 v30, v66, v66, v18
    v_perm_b32 v31, v66, v66, v19
    buffer_load_dwordx4 a[164:167], v4, s[32:35], s75 offen offset:1024 nt
    buffer_load_dwordx4 a[168:171], v4, s[32:35], s75 offen offset:2048 nt
    buffer_load_dwordx4 a[172:175], v4, s[32:35], s75 offen offset:3072 nt
    s_mov_b32 s75, 0xa1000
    buffer_load_dwordx4 a[176:179], v4, s[32:35], s75 offen offset:0 nt
    s_waitcnt vmcnt(11)
    v_mfma_f32_16x16x32_bf16 v[36:39], v[32:35], a[132:135], v[36:39]
    v_mov_b32_dpp v67, v60 row_newbcast:12 row_mask:0xf bank_mask:0xf
    v_perm_b32 v32, v67, v67, v16
    v_perm_b32 v33, v67, v67, v17
    v_perm_b32 v34, v67, v67, v18
    v_perm_b32 v35, v67, v67, v19
    buffer_load_dwordx4 a[180:183], v4, s[32:35], s75 offen offset:1024 nt
    s_waitcnt vmcnt(11)
    v_mfma_f32_16x16x32_bf16 v[36:39], v[28:31], a[136:139], v[36:39]
    ds_read_b128 v[88:91], v14 offset:8192
    ds_read_b128 v[92:95], v14 offset:9216
    ds_read_b128 v[96:99], v14 offset:10240
    ds_read_b128 v[100:103], v14 offset:11264
    ds_read_b128 v[104:107], v14 offset:12288
    ds_read_b128 v[108:111], v14 offset:13312
    ds_read_b128 v[112:115], v14 offset:14336
    ds_read_b128 v[116:119], v14 offset:15360
    s_waitcnt lgkmcnt(0)
    v_perm_b32 v124, v92, v88, s20
    v_perm_b32 v125, v100, v96, s20
    v_perm_b32 v126, v108, v104, s20
    v_perm_b32 v127, v116, v112, s20
    v_perm_b32 v132, v92, v88, s21
    v_perm_b32 v133, v100, v96, s21
    v_perm_b32 v134, v108, v104, s21
    v_perm_b32 v135, v116, v112, s21
    v_perm_b32 v140, v93, v89, s20
    v_perm_b32 v141, v101, v97, s20
    v_perm_b32 v142, v109, v105, s20
    buffer_load_dwordx4 a[184:187], v4, s[32:35], s75 offen offset:2048 nt
    v_perm_b32 v143, v117, v113, s20
    v_perm_b32 v148, v93, v89, s21
    v_perm_b32 v149, v101, v97, s21
    v_perm_b32 v150, v109, v105, s21
    v_perm_b32 v151, v117, v113, s21
    v_perm_b32 v156, v94, v90, s20
    v_perm_b32 v157, v102, v98, s20
    v_perm_b32 v158, v110, v106, s20
    v_perm_b32 v159, v118, v114, s20
    v_perm_b32 v164, v94, v90, s21
    v_perm_b32 v165, v102, v98, s21
    v_perm_b32 v166, v110, v106, s21
    v_perm_b32 v167, v118, v114, s21
    v_perm_b32 v172, v95, v91, s20
    v_perm_b32 v173, v103, v99, s20
    v_perm_b32 v174, v111, v107, s20
    v_perm_b32 v175, v119, v115, s20
    v_perm_b32 v180, v95, v91, s21
    v_perm_b32 v181, v103, v99, s21
    v_perm_b32 v182, v111, v107, s21
    v_perm_b32 v183, v119, v115, s21
    v_perm_b32 v28, v64, v64, v20
    v_perm_b32 v29, v64, v64, v21
    v_perm_b32 v30, v64, v64, v22
    v_perm_b32 v31, v64, v64, v23
    s_waitcnt vmcnt(11)
    v_mfma_f32_16x16x32_bf16 v[36:39], v[32:35], a[140:143], v[36:39]
    v_perm_b32 v32, v65, v65, v20
    v_perm_b32 v33, v65, v65, v21
    v_perm_b32 v34, v65, v65, v22
    v_perm_b32 v35, v65, v65, v23
    buffer_load_dwordx4 a[188:191], v4, s[32:35], s75 offen offset:3072 nt
    s_waitcnt vmcnt(11)
    v_mfma_f32_16x16x32_bf16 v[36:39], v[28:31], a[144:147], v[36:39]
    v_perm_b32 v28, v66, v66, v20
    v_perm_b32 v29, v66, v66, v21
    v_perm_b32 v30, v66, v66, v22
    v_perm_b32 v31, v66, v66, v23
    s_mov_b32 s75, 0x60000
    buffer_load_dwordx4 a[192:195], v4, s[32:35], s75 offen offset:0 nt
    s_waitcnt vmcnt(11)
    v_mfma_f32_16x16x32_bf16 v[36:39], v[32:35], a[148:151], v[36:39]
    ds_read_b128 v[88:91], v14 offset:16384
    ds_read_b128 v[92:95], v14 offset:17408
    ds_read_b128 v[96:99], v14 offset:18432
    ds_read_b128 v[100:103], v14 offset:19456
    ds_read_b128 v[104:107], v14 offset:20480
    ds_read_b128 v[108:111], v14 offset:21504
    ds_read_b128 v[112:115], v14 offset:22528
    ds_read_b128 v[116:119], v14 offset:23552
    s_waitcnt lgkmcnt(0)
    v_perm_b32 v184, v92, v88, s20
    v_perm_b32 v185, v100, v96, s20
    v_perm_b32 v186, v108, v104, s20
    v_perm_b32 v187, v116, v112, s20
    v_perm_b32 v192, v92, v88, s21
    v_perm_b32 v193, v100, v96, s21
    v_perm_b32 v194, v108, v104, s21
    v_perm_b32 v195, v116, v112, s21
    v_perm_b32 v200, v93, v89, s20
    v_perm_b32 v201, v101, v97, s20
    v_perm_b32 v202, v109, v105, s20
    buffer_load_dwordx4 a[196:199], v4, s[32:35], s75 offen offset:1024 nt
    v_perm_b32 v203, v117, v113, s20
    v_perm_b32 v208, v93, v89, s21
    v_perm_b32 v209, v101, v97, s21
    v_perm_b32 v210, v109, v105, s21
    v_perm_b32 v211, v117, v113, s21
    v_perm_b32 v216, v94, v90, s20
    v_perm_b32 v217, v102, v98, s20
    v_perm_b32 v218, v110, v106, s20
    v_perm_b32 v219, v118, v114, s20
    v_perm_b32 v224, v94, v90, s21
    v_perm_b32 v225, v102, v98, s21
    v_perm_b32 v226, v110, v106, s21
    v_perm_b32 v227, v118, v114, s21
    v_perm_b32 v232, v95, v91, s20
    v_perm_b32 v233, v103, v99, s20
    v_perm_b32 v234, v111, v107, s20
    v_perm_b32 v235, v119, v115, s20
    v_perm_b32 v240, v95, v91, s21
    v_perm_b32 v241, v103, v99, s21
    v_perm_b32 v242, v111, v107, s21
    v_perm_b32 v243, v119, v115, s21
    v_perm_b32 v32, v67, v67, v20
    v_perm_b32 v33, v67, v67, v21
    v_perm_b32 v34, v67, v67, v22
    v_perm_b32 v35, v67, v67, v23
    s_waitcnt vmcnt(11)
    v_mfma_f32_16x16x32_bf16 v[36:39], v[28:31], a[152:155], v[36:39]
    v_mov_b32_dpp v64, v61 row_newbcast:0 row_mask:0xf bank_mask:0xf
    v_perm_b32 v28, v64, v64, v16
    v_perm_b32 v29, v64, v64, v17
    v_perm_b32 v30, v64, v64, v18
    v_perm_b32 v31, v64, v64, v19
    buffer_load_dwordx4 a[200:203], v4, s[32:35], s75 offen offset:2048 nt
    s_waitcnt vmcnt(11)
    v_mfma_f32_16x16x32_bf16 v[36:39], v[32:35], a[156:159], v[36:39]
    v_mov_b32_dpp v65, v61 row_newbcast:8 row_mask:0xf bank_mask:0xf
    v_perm_b32 v32, v65, v65, v16
    v_perm_b32 v33, v65, v65, v17
    v_perm_b32 v34, v65, v65, v18
    v_perm_b32 v35, v65, v65, v19
    buffer_load_dwordx4 a[204:207], v4, s[32:35], s75 offen offset:3072 nt
    s_waitcnt vmcnt(11)
    v_mfma_f32_16x16x32_bf16 v[36:39], v[28:31], a[160:163], v[36:39]
    ds_read_b128 v[88:91], v14 offset:24576
    ds_read_b128 v[92:95], v14 offset:25600
    ds_read_b128 v[96:99], v14 offset:26624
    ds_read_b128 v[100:103], v14 offset:27648
    ds_read_b128 v[104:107], v14 offset:28672
    ds_read_b128 v[108:111], v14 offset:29696
    ds_read_b128 v[112:115], v14 offset:30720
    ds_read_b128 v[116:119], v14 offset:31744
    s_waitcnt lgkmcnt(0)
    v_perm_b32 v188, v92, v88, s20
    v_perm_b32 v189, v100, v96, s20
    v_perm_b32 v190, v108, v104, s20
    v_perm_b32 v191, v116, v112, s20
    v_perm_b32 v196, v92, v88, s21
    v_perm_b32 v197, v100, v96, s21
    v_perm_b32 v198, v108, v104, s21
    v_perm_b32 v199, v116, v112, s21
    v_perm_b32 v204, v93, v89, s20
    v_perm_b32 v205, v101, v97, s20
    v_perm_b32 v206, v109, v105, s20
    s_mov_b32 s75, 0x61000
    buffer_load_dwordx4 a[208:211], v4, s[32:35], s75 offen offset:0 nt
    v_perm_b32 v207, v117, v113, s20
    v_perm_b32 v212, v93, v89, s21
    v_perm_b32 v213, v101, v97, s21
    v_perm_b32 v214, v109, v105, s21
    v_perm_b32 v215, v117, v113, s21
    v_perm_b32 v220, v94, v90, s20
    v_perm_b32 v221, v102, v98, s20
    v_perm_b32 v222, v110, v106, s20
    v_perm_b32 v223, v118, v114, s20
    v_perm_b32 v228, v94, v90, s21
    v_perm_b32 v229, v102, v98, s21
    v_perm_b32 v230, v110, v106, s21
    v_perm_b32 v231, v118, v114, s21
    v_perm_b32 v236, v95, v91, s20
    v_perm_b32 v237, v103, v99, s20
    v_perm_b32 v238, v111, v107, s20
    v_perm_b32 v239, v119, v115, s20
    v_perm_b32 v244, v95, v91, s21
    v_perm_b32 v245, v103, v99, s21
    v_perm_b32 v246, v111, v107, s21
    v_perm_b32 v247, v119, v115, s21
    v_mov_b32_dpp v66, v61 row_newbcast:4 row_mask:0xf bank_mask:0xf
    v_perm_b32 v28, v66, v66, v16
    v_perm_b32 v29, v66, v66, v17
    v_perm_b32 v30, v66, v66, v18
    v_perm_b32 v31, v66, v66, v19
    s_waitcnt vmcnt(11)
    v_mfma_f32_16x16x32_bf16 v[36:39], v[32:35], a[164:167], v[36:39]
    v_mov_b32_dpp v67, v61 row_newbcast:12 row_mask:0xf bank_mask:0xf
    v_perm_b32 v32, v67, v67, v16
    v_perm_b32 v33, v67, v67, v17
    v_perm_b32 v34, v67, v67, v18
    v_perm_b32 v35, v67, v67, v19
    buffer_load_dwordx4 a[212:215], v4, s[32:35], s75 offen offset:1024 nt
    s_waitcnt vmcnt(11)
    v_mfma_f32_16x16x32_bf16 v[36:39], v[28:31], a[168:171], v[36:39]
    v_perm_b32 v28, v64, v64, v20
    v_perm_b32 v29, v64, v64, v21
    v_perm_b32 v30, v64, v64, v22
    v_perm_b32 v31, v64, v64, v23
    buffer_load_dwordx4 a[216:219], v4, s[32:35], s75 offen offset:2048 nt
    s_waitcnt vmcnt(11)
    v_mfma_f32_16x16x32_bf16 v[36:39], v[32:35], a[172:175], v[36:39]
    s_cmp_eq_u32 s86, 0
    s_cbranch_scc1 L_pre_done
    s_mov_b32 s3, 0
L_pre_chk:
    v_xor_b32 v248, s24, v248
    v_xor_b32 v249, s24, v249
    v_xor_b32 v250, s24, v250
    v_xor_b32 v251, s24, v251
    v_xor_b32 v252, s24, v252
    v_xor_b32 v253, s24, v253
    v_xor_b32 v254, s24, v254
    v_xor_b32 v255, s24, v255
    v_or3_b32 v12, v248, v249, v250
    v_or3_b32 v12, v12, v251, v252
    v_or3_b32 v12, v12, v253, v254
    v_or_b32 v12, v12, v255
    v_and_b32 v12, 0x3ff, v12
    v_cmp_ne_u32 vcc, 0, v12
    s_add_u32 s3, s3, 1
    s_cbranch_vccz L_pre_ok
    s_cmp_ge_u32 s3, 0x40000
    s_cbranch_scc1 L_pre_ok
    buffer_load_dwordx4 v[248:251], v10, s[60:63], 0 offen sc1
    buffer_load_dwordx4 v[252:255], v11, s[60:63], 0 offen sc1
    s_waitcnt vmcnt(0)
    s_branch L_pre_chk
L_pre_ok:
    v_cmp_ne_u32 vcc, v10, v11
    s_nop 1
    v_cndmask_b32 v252, 0, v252, vcc
    v_cndmask_b32 v253, 0, v253, vcc
    v_cndmask_b32 v254, 0, v254, vcc
    v_cndmask_b32 v255, 0, v255, vcc
    v_add_f32 v48, v248, v252
    v_add_f32 v49, v249, v253
    v_add_f32 v50, v250, v254
    v_add_f32 v51, v251, v255
    v_lshlrev_b32 v26, 16, v26
    v_and_b32 v52, 7, v0
    v_and_b32 v12, 1, v3
    v_lshl_add_u32 v52, v52, 1, v12
    v_lshrrev_b32 v12, 1, v3
    v_lshl_add_u32 v52, v52, 1, v12
    s_lshl_b32 s76, s70, 2
    v_lshl_add_u32 v52, v52, 4, s76
    s_nop 0
    v_permlane32_swap_b32 v48, v49
    v_permlane32_swap_b32 v50, v51
    v_add_f32 v48, v48, v49
    v_add_f32 v50, v50, v51
    s_nop 1
    v_permlane16_swap_b32 v48, v50
    v_add_f32 v48, v48, v50
    s_nop 1
    v_add_f32_dpp v48, v48, v48 row_ror:8 row_mask:0xf bank_mask:0xf
    ds_write_b32 v52, v48 offset:12288
L_pre_done:
    v_perm_b32 v32, v65, v65, v20
    buffer_load_dwordx4 a[220:223], v4, s[32:35], s75 offen offset:3072 nt
    v_perm_b32 v33, v65, v65, v21
    v_perm_b32 v34, v65, v65, v22
    v_perm_b32 v35, v65, v65, v23
    s_waitcnt vmcnt(11)
    v_mfma_f32_16x16x32_bf16 v[36:39], v[28:31], a[176:179], v[36:39]
    v_perm_b32 v28, v66, v66, v20
    v_perm_b32 v29, v66, v66, v21
    v_perm_b32 v30, v66, v66, v22
    v_perm_b32 v31, v66, v66, v23
    s_mov_b32 s75, 0xe0000
    buffer_load_dwordx4 a[224:227], v4, s[32:35], s75 offen offset:0 nt
    buffer_load_dwordx4 a[228:231], v4, s[32:35], s75 offen offset:1024 nt
    buffer_load_dwordx4 a[232:235], v4, s[32:35], s75 offen offset:2048 nt
    buffer_load_dwordx4 a[236:239], v4, s[32:35], s75 offen offset:3072 nt
    s_mov_b32 s75, 0xe1000
    buffer_load_dwordx4 a[240:243], v4, s[32:35], s75 offen offset:0 nt
    s_waitcnt vmcnt(15)
    v_mfma_f32_16x16x32_bf16 v[36:39], v[32:35], a[180:183], v[36:39]
    s_mul_i32 s76, s70, 0x140
    v_and_b32 v10, 3, v1
    v_mul_u32_u24 v10, 320, v10
    s_add_u32 s76, s76, 0x5880
    v_lshrrev_b32 v9, 1, v2
    v_lshl_add_u32 v9, v9, 5, s76
    v_and_b32 v11, 1, v2
    v_lshl_add_u32 v9, v11, 3, v9
    v_lshl_add_u32 v9, v3, 2, v9
    v_bfe_u32 v11, v2, 2, 1
    v_cmp_eq_u32 vcc, 1, v11
    v_lshl_add_u32 v10, v3, 5, v10
    v_lshl_add_u32 v10, v11, 4, v10
    v_mov_b32 v5, 0x44444444
    v_mov_b32 v11, 0xeeeeeeee
    v_cndmask_b32 v5, v5, v11, vcc
    v_mov_b32 v88, 0
    v_mov_b32 v89, 0
    v_mov_b32 v90, 0
    v_mov_b32 v91, 0
    v_mov_b32 v92, 0
    v_mov_b32 v93, 0
    v_mov_b32 v94, 0
    v_mov_b32 v95, 0
    v_mov_b32 v96, 0
    v_mov_b32 v97, 0
    v_mov_b32 v98, 0
    v_mov_b32 v99, 0
    v_mov_b32 v100, 0
    v_mov_b32 v101, 0
    v_mov_b32 v102, 0
    v_mov_b32 v103, 0
    v_mov_b32 v104, 0
    v_mov_b32 v105, 0
    v_mov_b32 v106, 0
    v_mov_b32 v107, 0
    v_mov_b32 v108, 0
    v_mov_b32 v109, 0
    v_mov_b32 v110, 0
    v_mov_b32 v111, 0
    v_mov_b32 v112, 0
    v_mov_b32 v113, 0
    v_mov_b32 v114, 0
    v_mov_b32 v115, 0
    v_mov_b32 v116, 0
    v_mov_b32 v117, 0
    v_mov_b32 v118, 0
    v_mov_b32 v119, 0
    s_lshl_b32 s76, s73, 11
    buffer_load_dwordx4 a[244:247], v4, s[32:35], s75 offen offset:1024 nt
    s_lshl_b32 s77, s70, 9
    s_add_u32 s76, s76, s77
    v_lshl_add_u32 v11, v2, 5, s76
    v_lshl_add_u32 v11, v3, 4, v11
    v_cmp_eq_u32 vcc, 1, v3
    v_mov_b32 v12, 0x3ff
    v_perm_b32 v32, v67, v67, v20
    v_perm_b32 v33, v67, v67, v21
    v_perm_b32 v34, v67, v67, v22
    v_perm_b32 v35, v67, v67, v23
    s_waitcnt vmcnt(15)
    v_mfma_f32_16x16x32_bf16 v[36:39], v[28:31], a[184:187], v[36:39]
    v_mov_b32_dpp v64, v62 row_newbcast:0 row_mask:0xf bank_mask:0xf
    v_perm_b32 v28, v64, v64, v16
    v_perm_b32 v29, v64, v64, v17
    v_perm_b32 v30, v64, v64, v18
    v_perm_b32 v31, v64, v64, v19
    buffer_load_dwordx4 a[248:251], v4, s[32:35], s75 offen offset:2048 nt
    s_waitcnt vmcnt(15)
    v_mfma_f32_16x16x32_bf16 v[36:39], v[32:35], a[188:191], v[36:39]
    v_mov_b32_dpp v65, v62 row_newbcast:8 row_mask:0xf bank_mask:0xf
    v_perm_b32 v32, v65, v65, v16
    v_perm_b32 v33, v65, v65, v17
    v_perm_b32 v34, v65, v65, v18
    v_perm_b32 v35, v65, v65, v19
    buffer_load_dwordx4 a[252:255], v4, s[32:35], s75 offen offset:3072 nt
    s_waitcnt vmcnt(15)
    v_mfma_f32_16x16x32_bf16 v[36:39], v[28:31], a[192:195], v[36:39]
    v_mov_b32_dpp v66, v62 row_newbcast:4 row_mask:0xf bank_mask:0xf
    v_perm_b32 v28, v66, v66, v16
    v_perm_b32 v29, v66, v66, v17
    v_perm_b32 v30, v66, v66, v18
    v_perm_b32 v31, v66, v66, v19
    s_waitcnt vmcnt(14)
    v_mfma_f32_16x16x32_bf16 v[36:39], v[32:35], a[196:199], v[36:39]
    v_mov_b32_dpp v67, v62 row_newbcast:12 row_mask:0xf bank_mask:0xf
    v_perm_b32 v32, v67, v67, v16
    v_perm_b32 v33, v67, v67, v17
    v_perm_b32 v34, v67, v67, v18
    v_perm_b32 v35, v67, v67, v19
    s_waitcnt vmcnt(13)
    v_mfma_f32_16x16x32_bf16 v[36:39], v[28:31], a[200:203], v[36:39]
    v_perm_b32 v28, v64, v64, v20
    v_perm_b32 v29, v64, v64, v21
    v_perm_b32 v30, v64, v64, v22
    v_perm_b32 v31, v64, v64, v23
    s_waitcnt vmcnt(12)
    v_mfma_f32_16x16x32_bf16 v[36:39], v[32:35], a[204:207], v[36:39]
    v_perm_b32 v32, v65, v65, v20
    v_perm_b32 v33, v65, v65, v21
    v_perm_b32 v34, v65, v65, v22
    v_perm_b32 v35, v65, v65, v23
    s_waitcnt vmcnt(11)
    v_mfma_f32_16x16x32_bf16 v[36:39], v[28:31], a[208:211], v[36:39]
    v_perm_b32 v28, v66, v66, v20
    v_perm_b32 v29, v66, v66, v21
    v_perm_b32 v30, v66, v66, v22
    v_perm_b32 v31, v66, v66, v23
    s_waitcnt vmcnt(10)
    v_mfma_f32_16x16x32_bf16 v[36:39], v[32:35], a[212:215], v[36:39]
    v_perm_b32 v32, v67, v67, v20
    v_perm_b32 v33, v67, v67, v21
    v_perm_b32 v34, v67, v67, v22
    v_perm_b32 v35, v67, v67, v23
    s_waitcnt vmcnt(9)
    v_mfma_f32_16x16x32_bf16 v[36:39], v[28:31], a[216:219], v[36:39]
    v_mov_b32_dpp v64, v63 row_newbcast:0 row_mask:0xf bank_mask:0xf
    v_perm_b32 v28, v64, v64, v16
    v_perm_b32 v29, v64, v64, v17
    v_perm_b32 v30, v64, v64, v18
    v_perm_b32 v31, v64, v64, v19
    s_waitcnt vmcnt(8)
    v_mfma_f32_16x16x32_bf16 v[36:39], v[32:35], a[220:223], v[36:39]
    v_mov_b32_dpp v65, v63 row_newbcast:8 row_mask:0xf bank_mask:0xf
    v_perm_b32 v32, v65, v65, v16
    v_perm_b32 v33, v65, v65, v17
    v_perm_b32 v34, v65, v65, v18
    v_perm_b32 v35, v65, v65, v19
    s_waitcnt vmcnt(7)
    v_mfma_f32_16x16x32_bf16 v[36:39], v[28:31], a[224:227], v[36:39]
    v_mov_b32_dpp v66, v63 row_newbcast:4 row_mask:0xf bank_mask:0xf
    v_perm_b32 v28, v66, v66, v16
    v_perm_b32 v29, v66, v66, v17
    v_perm_b32 v30, v66, v66, v18
    v_perm_b32 v31, v66, v66, v19
    s_waitcnt vmcnt(6)
    v_mfma_f32_16x16x32_bf16 v[36:39], v[32:35], a[228:231], v[36:39]
    v_mov_b32_dpp v67, v63 row_newbcast:12 row_mask:0xf bank_mask:0xf
    v_perm_b32 v32, v67, v67, v16
    v_perm_b32 v33, v67, v67, v17
    v_perm_b32 v34, v67, v67, v18
    v_perm_b32 v35, v67, v67, v19
    s_waitcnt vmcnt(5)
    v_mfma_f32_16x16x32_bf16 v[36:39], v[28:31], a[232:235], v[36:39]
    v_perm_b32 v28, v64, v64, v20
    v_perm_b32 v29, v64, v64, v21
    v_perm_b32 v30, v64, v64, v22
    v_perm_b32 v31, v64, v64, v23
    s_waitcnt vmcnt(4)
    v_mfma_f32_16x16x32_bf16 v[36:39], v[32:35], a[236:239], v[36:39]
    v_perm_b32 v32, v65, v65, v20
    v_perm_b32 v33, v65, v65, v21
    v_perm_b32 v34, v65, v65, v22
    v_perm_b32 v35, v65, v65, v23
    s_waitcnt vmcnt(3)
    v_mfma_f32_16x16x32_bf16 v[36:39], v[28:31], a[240:243], v[36:39]
    v_perm_b32 v28, v66, v66, v20
    v_perm_b32 v29, v66, v66, v21
    v_perm_b32 v30, v66, v66, v22
    v_perm_b32 v31, v66, v66, v23
    s_waitcnt vmcnt(2)
    v_mfma_f32_16x16x32_bf16 v[36:39], v[32:35], a[244:247], v[36:39]
    v_perm_b32 v32, v67, v67, v20
    v_perm_b32 v33, v67, v67, v21
    v_perm_b32 v34, v67, v67, v22
    v_perm_b32 v35, v67, v67, v23
    s_waitcnt vmcnt(1)
    v_mfma_f32_16x16x32_bf16 v[36:39], v[28:31], a[248:251], v[36:39]
    s_waitcnt vmcnt(0)
    v_mfma_f32_16x16x32_bf16 v[36:39], v[32:35], a[252:255], v[36:39]
    s_nop 6
    s_mov_b32 exec_hi, 0
    v_cvt_pk_bf16_f32 v28, v36, v37
    v_cvt_pk_bf16_f32 v29, v38, v39
    ds_write2_b32 v9, v28, v29 offset0:0 offset1:4
    s_mov_b64 exec, -1
    s_waitcnt lgkmcnt(0)
    s_barrier
    ds_read_b128 v[56:59], v10 offset:22656
    ds_read_b128 v[60:63], v10 offset:22784
    s_waitcnt lgkmcnt(1)
    v_smfmac_f32_16x16x64_bf16 v[88:91], v[56:59], v[120:127], v5
    v_smfmac_f32_16x16x64_bf16 v[104:107], v[56:59], v[152:159], v5
    v_smfmac_f32_16x16x64_bf16 v[92:95], v[56:59], v[128:135], v5
    v_smfmac_f32_16x16x64_bf16 v[108:111], v[56:59], v[160:167], v5
    v_smfmac_f32_16x16x64_bf16 v[96:99], v[56:59], v[136:143], v5
    v_smfmac_f32_16x16x64_bf16 v[112:115], v[56:59], v[168:175], v5
    v_smfmac_f32_16x16x64_bf16 v[100:103], v[56:59], v[144:151], v5
    v_smfmac_f32_16x16x64_bf16 v[116:119], v[56:59], v[176:183], v5
    s_waitcnt lgkmcnt(0)
    v_smfmac_f32_16x16x64_bf16 v[88:91], v[60:63], v[184:191], v5
    v_smfmac_f32_16x16x64_bf16 v[104:107], v[60:63], v[216:223], v5
    v_smfmac_f32_16x16x64_bf16 v[92:95], v[60:63], v[192:199], v5
    v_smfmac_f32_16x16x64_bf16 v[108:111], v[60:63], v[224:231], v5
    v_smfmac_f32_16x16x64_bf16 v[96:99], v[60:63], v[200:207], v5
    v_smfmac_f32_16x16x64_bf16 v[112:115], v[60:63], v[232:239], v5
    v_smfmac_f32_16x16x64_bf16 v[100:103], v[60:63], v[208:215], v5
    v_smfmac_f32_16x16x64_bf16 v[116:119], v[60:63], v[240:247], v5
    s_nop 0
    v_pk_add_f32 v[88:89], v[88:89], v[90:91]
    v_pk_add_f32 v[104:105], v[104:105], v[106:107]
    v_pk_add_f32 v[92:93], v[92:93], v[94:95]
    v_pk_add_f32 v[108:109], v[108:109], v[110:111]
    v_pk_add_f32 v[96:97], v[96:97], v[98:99]
    v_pk_add_f32 v[112:113], v[112:113], v[114:115]
    v_pk_add_f32 v[100:101], v[100:101], v[102:103]
    v_pk_add_f32 v[116:117], v[116:117], v[118:119]
    v_add_f32 v88, v88, v89
    v_add_f32 v104, v104, v105
    v_add_f32 v92, v92, v93
    v_add_f32 v108, v108, v109
    v_add_f32 v96, v96, v97
    v_add_f32 v112, v112, v113
    v_add_f32 v100, v100, v101
    v_add_f32 v116, v116, v117
    v_permlane16_swap_b32 v88, v104
    v_permlane16_swap_b32 v92, v108
    v_permlane16_swap_b32 v96, v112
    v_permlane16_swap_b32 v100, v116
    v_add_f32 v56, v88, v104
    v_add_f32 v57, v92, v108
    v_add_f32 v58, v96, v112
    v_add_f32 v59, v100, v116
    v_bfi_b32 v56, v12, s24, v56
    v_bfi_b32 v57, v12, s24, v57
    v_bfi_b32 v58, v12, s24, v58
    v_bfi_b32 v59, v12, s24, v59
    s_mov_b32 exec_hi, 0
    buffer_store_dwordx4 v[56:59], v11, s[52:55], 0 offen sc1
    s_mov_b64 exec, -1
    s_cmp_eq_u32 s86, 0
    s_cbranch_scc1 L_fin_done
    s_mov_b32 s76, 0x10000
    s_mov_b32 s77, 0x20000
    s_mov_b32 s78, 0x30000
    buffer_load_dwordx4 v[72:75], v27, s[60:63], 0 offen offset:0 sc1
    buffer_load_dwordx4 v[76:79], v27, s[60:63], 0 offen offset:512 sc1
    buffer_load_dwordx4 v[80:83], v27, s[60:63], 0 offen offset:1024 sc1
    buffer_load_dwordx4 v[84:87], v27, s[60:63], 0 offen offset:1536 sc1
    buffer_load_dwordx4 v[88:91], v24, s[60:63], 0 offen sc1
    buffer_load_dwordx4 v[92:95], v24, s[60:63], s76 offen sc1
    buffer_load_dwordx4 v[96:99], v24, s[60:63], s77 offen sc1
    buffer_load_dwordx4 v[100:103], v24, s[60:63], s78 offen sc1
    s_waitcnt vmcnt(4)
    s_mov_b32 s3, 0
L_ml_chk:
    v_xor_b32 v72, s24, v72
    v_xor_b32 v73, s24, v73
    v_xor_b32 v74, s24, v74
    v_xor_b32 v75, s24, v75
    v_xor_b32 v76, s24, v76
    v_xor_b32 v77, s24, v77
    v_xor_b32 v78, s24, v78
    v_xor_b32 v79, s24, v79
    v_xor_b32 v80, s24, v80
    v_xor_b32 v81, s24, v81
    v_xor_b32 v82, s24, v82
    v_xor_b32 v83, s24, v83
    v_xor_b32 v84, s24, v84
    v_xor_b32 v85, s24, v85
    v_xor_b32 v86, s24, v86
    v_xor_b32 v87, s24, v87
    v_or3_b32 v248, v72, v73, v74
    v_or3_b32 v248, v248, v75, v76
    v_or3_b32 v248, v248, v77, v78
    v_or3_b32 v248, v248, v79, v80
    v_or3_b32 v248, v248, v81, v82
    v_or3_b32 v248, v248, v83, v84
    v_or3_b32 v248, v248, v85, v86
    v_or_b32 v248, v248, v87
    v_and_b32 v248, 0x3ff, v248
    v_cmp_ne_u32 vcc, 0, v248
    s_add_u32 s3, s3, 1
    s_cbranch_vccz L_ml_ok
    s_cmp_ge_u32 s3, 0x40000
    s_cbranch_scc1 L_ml_ok
    buffer_load_dwordx4 v[72:75], v27, s[60:63], 0 offen offset:0 sc1
    buffer_load_dwordx4 v[76:79], v27, s[60:63], 0 offen offset:512 sc1
    buffer_load_dwordx4 v[80:83], v27, s[60:63], 0 offen offset:1024 sc1
    buffer_load_dwordx4 v[84:87], v27, s[60:63], 0 offen offset:1536 sc1
    s_waitcnt vmcnt(0)
    s_branch L_ml_chk
L_ml_ok:
    v_max_f32_dpp v248, v72, v72 row_ror:8 row_mask:0xf bank_mask:0xf
    v_max_f32_dpp v249, v76, v76 row_ror:8 row_mask:0xf bank_mask:0xf
    v_max_f32_dpp v250, v80, v80 row_ror:8 row_mask:0xf bank_mask:0xf
    v_max_f32_dpp v251, v84, v84 row_ror:8 row_mask:0xf bank_mask:0xf
    v_mov_b32 v252, v248
    v_mov_b32 v253, v249
    v_mov_b32 v254, v250
    v_mov_b32 v255, v251
    v_permlane16_swap_b32 v248, v252
    v_permlane16_swap_b32 v249, v253
    v_permlane16_swap_b32 v250, v254
    v_permlane16_swap_b32 v251, v255
    v_max_f32 v248, v248, v252
    v_max_f32 v249, v249, v253
    v_max_f32 v250, v250, v254
    v_max_f32 v251, v251, v255
    v_sub_f32 v40, v72, v248
    v_sub_f32 v42, v76, v249
    v_sub_f32 v44, v80, v250
    v_sub_f32 v46, v84, v251
    v_mul_f32 v40, s23, v40
    v_mul_f32 v42, s23, v42
    v_mul_f32 v44, s23, v44
    v_mul_f32 v46, s23, v46
    v_exp_f32 v40, v40
    v_exp_f32 v42, v42
    v_exp_f32 v44, v44
    v_exp_f32 v46, v46
    v_mul_f32 v41, v73, v40
    v_mul_f32 v43, v77, v42
    v_mul_f32 v45, v81, v44
    v_mul_f32 v47, v85, v46
    v_add_f32_dpp v41, v41, v41 row_ror:8 row_mask:0xf bank_mask:0xf
    v_add_f32_dpp v43, v43, v43 row_ror:8 row_mask:0xf bank_mask:0xf
    v_add_f32_dpp v45, v45, v45 row_ror:8 row_mask:0xf bank_mask:0xf
    v_add_f32_dpp v47, v47, v47 row_ror:8 row_mask:0xf bank_mask:0xf
    v_mov_b32 v252, v41
    v_mov_b32 v253, v43
    v_mov_b32 v254, v45
    v_mov_b32 v255, v47
    v_permlane16_swap_b32 v41, v252
    v_permlane16_swap_b32 v43, v253
    v_permlane16_swap_b32 v45, v254
    v_permlane16_swap_b32 v47, v255
    v_add_f32 v41, v41, v252
    v_add_f32 v43, v43, v253
    v_add_f32 v45, v45, v254
    v_add_f32 v47, v47, v255
    v_rcp_f32 v41, v41
    v_rcp_f32 v43, v43
    v_rcp_f32 v45, v45
    v_rcp_f32 v47, v47
    v_mul_f32 v40, v40, v41
    v_mul_f32 v42, v42, v43
    v_mul_f32 v44, v44, v45
    v_mul_f32 v46, v46, v47
    v_and_b32 v10, 31, v1
    v_lshlrev_b32 v10, 4, v10
    ds_read_b128 v[72:75], v10 offset:12288
    s_waitcnt lgkmcnt(0)
    v_add_f32 v72, v72, v73
    v_add_f32 v74, v74, v75
    v_add_f32 v72, v72, v74
    v_cvt_pk_bf16_f32 v72, v72, v72
    v_lshlrev_b32 v72, 16, v72
    s_mov_b32 s3, 0
    s_mov_b64 s[4:5], -1
    s_mov_b64 s[6:7], -1
    s_mov_b64 s[8:9], -1
    s_mov_b64 s[10:11], -1
    s_branch L_poll_chk
L_poll:
    s_mov_b64 exec, s[4:5]
    s_cbranch_execz L_pk0
    buffer_load_dwordx4 v[88:91], v24, s[60:63], 0 offen sc1
L_pk0:
    s_mov_b64 exec, s[6:7]
    s_cbranch_execz L_pk1
    buffer_load_dwordx4 v[92:95], v24, s[60:63], s76 offen sc1
L_pk1:
    s_mov_b64 exec, s[8:9]
    s_cbranch_execz L_pk2
    buffer_load_dwordx4 v[96:99], v24, s[60:63], s77 offen sc1
L_pk2:
    s_mov_b64 exec, s[10:11]
    s_cbranch_execz L_pk3
    buffer_load_dwordx4 v[100:103], v24, s[60:63], s78 offen sc1
L_pk3:
    s_mov_b64 exec, -1
L_poll_chk:
    s_add_u32 s3, s3, 1
    s_waitcnt vmcnt(0)
    v_xor_b32 v104, s24, v88
    v_xor_b32 v105, s24, v89
    v_xor_b32 v106, s24, v90
    v_xor_b32 v107, s24, v91
    v_xor_b32 v108, s24, v92
    v_xor_b32 v109, s24, v93
    v_xor_b32 v110, s24, v94
    v_xor_b32 v111, s24, v95
    v_xor_b32 v112, s24, v96
    v_xor_b32 v113, s24, v97
    v_xor_b32 v114, s24, v98
    v_xor_b32 v115, s24, v99
    v_xor_b32 v116, s24, v100
    v_xor_b32 v117, s24, v101
    v_xor_b32 v118, s24, v102
    v_xor_b32 v119, s24, v103
    v_or3_b32 v248, v104, v105, v106
    v_or3_b32 v249, v108, v109, v110
    v_or3_b32 v250, v112, v113, v114
    v_or3_b32 v251, v116, v117, v118
    v_or_b32 v248, v107, v248
    v_or_b32 v249, v111, v249
    v_or_b32 v250, v115, v250
    v_or_b32 v251, v119, v251
    v_and_b32 v248, 0x3ff, v248
    v_and_b32 v249, 0x3ff, v249
    v_and_b32 v250, 0x3ff, v250
    v_and_b32 v251, 0x3ff, v251
    v_cmp_ne_u32 s[4:5], 0, v248
    v_cmp_ne_u32 s[6:7], 0, v249
    v_cmp_ne_u32 s[8:9], 0, v250
    v_cmp_ne_u32 s[10:11], 0, v251
    s_cmp_ge_u32 s3, 0x40000
    s_cbranch_scc1 L_poll_out
    s_or_b64 vcc, s[4:5], s[6:7]
    s_or_b64 s[12:13], s[8:9], s[10:11]
    s_or_b64 vcc, vcc, s[12:13]
    s_cbranch_scc1 L_poll
L_poll_out:
L_poll_done:
    s_mov_b64 exec, -1
    v_pk_mul_f32 v[48:49], v[104:105], v[40:41] op_sel_hi:[1,0]
    v_pk_mul_f32 v[50:51], v[106:107], v[40:41] op_sel_hi:[1,0]
    v_pk_fma_f32 v[48:49], v[108:109], v[42:43], v[48:49] op_sel_hi:[1,0,1]
    v_pk_fma_f32 v[50:51], v[110:111], v[42:43], v[50:51] op_sel_hi:[1,0,1]
    v_pk_fma_f32 v[48:49], v[112:113], v[44:45], v[48:49] op_sel_hi:[1,0,1]
    v_pk_fma_f32 v[50:51], v[114:115], v[44:45], v[50:51] op_sel_hi:[1,0,1]
    v_pk_fma_f32 v[48:49], v[116:117], v[46:47], v[48:49] op_sel_hi:[1,0,1]
    v_pk_fma_f32 v[50:51], v[118:119], v[46:47], v[50:51] op_sel_hi:[1,0,1]
    s_nop 0
    s_nop 0
    v_permlane32_swap_b32 v48, v49
    v_permlane32_swap_b32 v50, v51
    v_add_f32 v48, v48, v49
    v_add_f32 v50, v50, v51
    s_nop 1
    v_permlane16_swap_b32 v48, v50
    v_add_f32 v48, v48, v50
    s_nop 1
    v_add_f32_dpp v48, v48, v48 row_ror:8 row_mask:0xf bank_mask:0xf
    ds_write_b32 v52, v48 offset:23936
    s_mov_b32 exec_hi, 0
    s_waitcnt lgkmcnt(0)
    s_barrier
    s_cmp_lg_u32 s70, 0
    s_cbranch_scc1 L_fin_done
    ds_read_b128 v[88:91], v10 offset:23936
    s_waitcnt lgkmcnt(0)
    v_pk_add_f32 v[88:89], v[88:89], v[90:91]
    v_add_f32 v88, v88, v89
    v_cvt_pk_bf16_f32 v88, v88, v88
    v_lshlrev_b32 v88, 16, v88
    v_add_f32 v88, v88, v26
    v_cvt_pk_bf16_f32 v88, v88, v88
    v_lshlrev_b32 v88, 16, v88
    v_add_f32 v88, v88, v72
    v_cvt_pk_bf16_f32 v88, v88, v88
    buffer_store_short v88, v25, s[64:67], 0 offen sc1
    s_cmp_lg_u32 s90, 0
    s_cbranch_scc1 L_fin_done
    v_mov_b32 v9, 0x102000
    v_mov_b32 v10, s25
    s_mov_b64 exec, 1
    buffer_store_dword v10, v9, s[52:55], 0 offen sc1
L_fin_done:
L_end:
    s_endpgm
.section .rodata,"a"
.p2align 6
.amdhsa_kernel parallel_sum__sliding_block_cached__glu_gated_swiglu__decode_kernel
  .amdhsa_next_free_vgpr 512
  .amdhsa_next_free_sgpr 102
  .amdhsa_accum_offset 256
  .amdhsa_group_segment_fixed_size 0
  .amdhsa_kernarg_size 96
  .amdhsa_user_sgpr_count 2
  .amdhsa_user_sgpr_kernarg_segment_ptr 1
  .amdhsa_system_sgpr_workgroup_id_x 1
.end_amdhsa_kernel
```
